```python
import torch

def _softmax(x, axis=-1):
    return torch.softmax(x, dim=axis)
def _gelu(x):
    return torch.nn.functional.gelu(x, approximate="tanh")
def _silu(x):
    return torch.nn.functional.silu(x)
def _sigmoid(x):
    return torch.sigmoid(x)
def _layernorm(x, axis=-1, eps=1e-5):
    m = x.mean(dim=axis, keepdim=True)
    v = x.var(dim=axis, keepdim=True, unbiased=False)
    return (x - m) / torch.sqrt(v + eps)
def _scatter_add(tgt, idx, src, axis=0):
    return tgt.clone().index_add_(axis, idx, src)
def _segment_sum(src, seg, n):
    out = torch.zeros((n,) + src.shape[1:], dtype=src.dtype)
    return out.index_add_(0, seg, src)
def _pad(x, pw):
    flat = tuple(v for pair in reversed(pw) for v in pair)
    return torch.nn.functional.pad(x, flat)

kernel_name = 'sequential_preLN__sliding_block_cached__glu_gated_geglu__decode'

def setup_inputs():

    _w = (lambda a: (lambda t: t.to(torch.bfloat16) if t.is_floating_point() else t)(torch.as_tensor(a)))
    def _A_setup():
        B, Sq, D = 1, 1, 448
        Hq, Hkv, Sk, Dh = 16, 8, 16384, 256
        assert Hq % Hkv == 0, (Hq, Hkv)
        return {
            "x": _w((lambda *s: torch.randn(*s, dtype=torch.bfloat16) * 0.05)(B, Sq, D)),
            "k_cache": _w((lambda *s: torch.randn(*s, dtype=torch.bfloat16) * 1.6)(B, Hkv, Sk, Dh)),
            "v_cache": _w((lambda *s: torch.randn(*s, dtype=torch.bfloat16) * 0.8)(B, Hkv, Sk, Dh)),
            "wq": _w((lambda *s: torch.randn(*s, dtype=torch.bfloat16) * 1.6)(D, Hq * Dh) * (D ** -0.5)),
            "wo": _w((lambda *s: torch.randn(*s, dtype=torch.bfloat16) * 0.8)(Hq * Dh, D) * ((Hq * Dh) ** -0.5)),
        }
    _A_in = _A_setup()

    def _B_setup():
        B, S, Dm, Df = 1, 1, 448, 1792
        return {
            "x": _w((lambda *s: torch.randn(*s, dtype=torch.bfloat16) * 0.05)(B, S, Dm)),
            "w_gate": _w((lambda *s: torch.randn(*s, dtype=torch.bfloat16) * 0.8)(Dm, Df) * (Dm ** -0.5)),
            "w_up": _w((lambda *s: torch.randn(*s, dtype=torch.bfloat16) * 0.8)(Dm, Df) * (Dm ** -0.5)),
            "w_down": _w((lambda *s: torch.randn(*s, dtype=torch.bfloat16) * 0.8)(Df, Dm) * (Df ** -0.5)),
        }
    _B_in = _B_setup()

    return {
        "A_x": _A_in["x"],
        "A_k_cache": _A_in["k_cache"],
        "A_v_cache": _A_in["v_cache"],
        "A_wq": _A_in["wq"],
        "A_wo": _A_in["wo"],
        "B_x": _B_in["x"],
        "B_w_gate": _B_in["w_gate"],
        "B_w_up": _B_in["w_up"],
        "B_w_down": _B_in["w_down"],
    }

def reference(A_x, A_k_cache, A_v_cache, A_wq, A_wo, B_x, B_w_gate, B_w_up, B_w_down):
    def _A_ref(x, k_cache, v_cache, wq, wo):
        B, Sq, D = x.shape
        Hq, Dh = 16, 256
        Hkv, Sk = k_cache.shape[1], k_cache.shape[2]
        W = min(4096, max(256, Sk // 4))
        rep = Hq // Hkv
        q = (lambda x, *d: x.permute(*d))((x @ wq).reshape(B, Sq, Hq, Dh), 0, 2, 1, 3)
        k = (lambda x, n, axis: torch.repeat_interleave(x, n, dim=axis))(k_cache[:, :, Sk - W:, :], rep, axis=1)
        v = (lambda x, n, axis: torch.repeat_interleave(x, n, dim=axis))(v_cache[:, :, Sk - W:, :], rep, axis=1)
        scores = torch.einsum("bhqd,bhkd->bhqk", q, k) * (Dh ** -0.5)
        p = _softmax(scores, axis=-1)
        o = torch.einsum("bhqk,bhkd->bhqd", p, v)
        return (lambda x, *d: x.permute(*d))(o, 0, 2, 1, 3).reshape(B, Sq, Hq * Dh) @ wo

    def _B_ref(x, w_gate, w_up, w_down):
        g = torch.einsum("bsd,df->bsf", x, w_gate)
        u = torch.einsum("bsd,df->bsf", x, w_up)
        h = _gelu(g) * u
        return torch.einsum("bsf,fd->bsd", h, w_down)

    x = A_x
    h = x + _A_ref(_layernorm(x, axis=-1), A_k_cache, A_v_cache, A_wq, A_wo)
    h2 = h + _B_ref(_layernorm(h, axis=-1), B_w_gate, B_w_up, B_w_down)
    return h2
```

```asm
; @launch grid=(256,1,1) block=(512,1,1) lds=153856
.amdgcn_target "amdgcn-amd-amdhsa--gfx950"
.text
.globl sequential_preLN__sliding_block_cached__glu_gated_geglu__decode_kernel
.p2align 8
.type sequential_preLN__sliding_block_cached__glu_gated_geglu__decode_kernel,@function
sequential_preLN__sliding_block_cached__glu_gated_geglu__decode_kernel:
  s_cmp_ge_u32 s2, 256
  s_cbranch_scc1 L_end
  s_load_dwordx16 s[44:59], s[0:1], 0
  s_load_dwordx8 s[60:67], s[0:1], 64
  v_lshrrev_b32 v4, 6, v0
  v_and_b32 v1, 63, v0
  v_readfirstlane_b32 s3, v4
  v_and_b32 v2, 15, v1
  v_lshrrev_b32 v3, 4, v1
  v_lshrrev_b32 v12, 2, v2
  v_and_b32 v13, 3, v2
  s_and_b32 s4, s2, 7
  s_lshr_b32 s5, s2, 3
  s_mov_b32 s7, 200000
  s_cmp_ge_u32 s3, 4
  s_cbranch_scc1 L_T
  s_lshl_b32 s68, s4, 23
  s_lshl_b32 s69, s5, 16
  s_add_u32 s97, s68, s69
  s_add_u32 s97, s97, 6291456
  s_lshl_b32 s68, s3, 10
  s_add_u32 s97, s97, s68
  s_lshl_b32 s96, s3, 14
  s_add_u32 s98, s96, 65536
  s_mov_b32 s99, s96
  v_lshrrev_b32 v4, 5, v1
  v_and_b32 v5, 31, v1
  v_xor_b32 v5, v5, v4
  v_lshlrev_b32 v5, 4, v5
  v_lshl_add_u32 v20, v4, 9, v5
  v_xor_b32 v21, 32, v20
  v_xor_b32 v22, 64, v20
  v_xor_b32 v23, 96, v20
  v_xor_b32 v24, 128, v20
  v_xor_b32 v25, 160, v20
  v_xor_b32 v26, 192, v20
  v_xor_b32 v27, 224, v20
  s_waitcnt lgkmcnt(0)
  s_mov_b32 s12, s46
  s_and_b32 s13, s47, 0xffff
  s_mov_b32 s14, 67108864
  s_mov_b32 s15, 0x20000
  s_barrier
  s_setprio 1
  s_mov_b32 m0, s96
  s_add_u32 s96, s96, 1024
  buffer_load_dwordx4 v20, s[12:15], s97 offen nt lds
  s_add_u32 s97, s97, 4096
  s_mov_b32 m0, s96
  s_add_u32 s96, s96, 1024
  buffer_load_dwordx4 v21, s[12:15], s97 offen nt lds
  s_add_u32 s97, s97, 4096
  s_mov_b32 m0, s96
  s_add_u32 s96, s96, 1024
  buffer_load_dwordx4 v22, s[12:15], s97 offen nt lds
  s_add_u32 s97, s97, 4096
  s_mov_b32 m0, s96
  s_add_u32 s96, s96, 1024
  buffer_load_dwordx4 v23, s[12:15], s97 offen nt lds
  s_add_u32 s97, s97, 4096
  s_mov_b32 m0, s96
  s_add_u32 s96, s96, 1024
  buffer_load_dwordx4 v24, s[12:15], s97 offen nt lds
  s_add_u32 s97, s97, 4096
  s_mov_b32 m0, s96
  s_add_u32 s96, s96, 1024
  buffer_load_dwordx4 v25, s[12:15], s97 offen nt lds
  s_add_u32 s97, s97, 4096
  s_mov_b32 m0, s96
  s_add_u32 s96, s96, 1024
  buffer_load_dwordx4 v26, s[12:15], s97 offen nt lds
  s_add_u32 s97, s97, 4096
  s_mov_b32 m0, s96
  s_add_u32 s96, s96, 1024
  buffer_load_dwordx4 v27, s[12:15], s97 offen nt lds
  s_add_u32 s97, s97, 4096
  s_branch L_A2
L_T:
  s_sub_u32 s79, s3, 4
  s_cmp_lg_u32 s79, 0
  s_cbranch_scc1 L_T_idle0
  s_setprio 3
  v_lshlrev_b32 v16, 4, v1
  v_lshrrev_b32 v4, 3, v1
  v_and_b32 v5, 7, v1
  v_bfe_u32 v6, v4, 1, 1
  v_lshlrev_b32 v6, 1, v6
  v_xor_b32 v6, v5, v6
  v_lshlrev_b32 v6, 4, v6
  v_lshl_add_u32 v18, v4, 13, v6
  v_xor_b32 v19, 64, v18
  s_lshr_b32 s68, s5, 3
  s_mul_i32 s97, s68, 917504
  s_and_b32 s69, s5, 7
  s_lshl_b32 s70, s4, 3
  s_add_u32 s69, s69, s70
  s_lshl_b32 s70, s69, 7
  s_add_u32 s97, s97, s70
  s_lshl_b32 s98, s68, 14
  s_lshl_b32 s70, s69, 8
  s_add_u32 s98, s98, s70
  s_add_u32 s98, s98, 8192
  s_mul_i32 s99, s68, 224
  s_waitcnt lgkmcnt(0)
  s_load_dword s6, s[66:67], 0
  s_mov_b32 s24, s44
  s_and_b32 s25, s45, 0xffff
  s_mov_b32 s26, 896
  s_mov_b32 s27, 0x20000
  s_mov_b32 s20, s50
  s_and_b32 s21, s51, 0xffff
  s_mov_b32 s22, 3670016
  s_mov_b32 s23, 0x20000
  buffer_load_dwordx4 v[32:35], v16, s[24:27], 0 offen
  s_mov_b32 s96, 131072
  s_mov_b32 m0, s96
  s_add_u32 s96, s96, 1024
  buffer_load_dwordx4 v18, s[20:23], s97 offen nt lds
  s_add_u32 s97, s97, 65536
  s_mov_b32 m0, s96
  s_add_u32 s96, s96, 1024
  buffer_load_dwordx4 v19, s[20:23], s97 offen nt lds
  s_add_u32 s97, s97, 65536
  s_mov_b32 m0, s96
  s_add_u32 s96, s96, 1024
  buffer_load_dwordx4 v18, s[20:23], s97 offen nt lds
  s_add_u32 s97, s97, 65536
  s_mov_b32 m0, s96
  s_add_u32 s96, s96, 1024
  buffer_load_dwordx4 v19, s[20:23], s97 offen nt lds
  s_add_u32 s97, s97, 65536
  s_mov_b32 m0, s96
  s_add_u32 s96, s96, 1024
  buffer_load_dwordx4 v18, s[20:23], s97 offen nt lds
  s_add_u32 s97, s97, 65536
  s_mov_b32 m0, s96
  s_add_u32 s96, s96, 1024
  buffer_load_dwordx4 v19, s[20:23], s97 offen nt lds
  s_add_u32 s97, s97, 65536
  s_mov_b32 m0, s96
  s_add_u32 s96, s96, 1024
  buffer_load_dwordx4 v18, s[20:23], s97 offen nt lds
  s_add_u32 s97, s97, 65536
  s_mov_b32 m0, s96
  s_add_u32 s96, s96, 1024
  buffer_load_dwordx4 v19, s[20:23], s97 offen nt lds
  s_add_u32 s97, s97, 65536
  s_mov_b32 m0, s96
  s_add_u32 s96, s96, 1024
  buffer_load_dwordx4 v18, s[20:23], s97 offen nt lds
  s_add_u32 s97, s97, 65536
  s_mov_b32 m0, s96
  s_add_u32 s96, s96, 1024
  buffer_load_dwordx4 v19, s[20:23], s97 offen nt lds
  s_add_u32 s97, s97, 65536
  s_mov_b32 m0, s96
  s_add_u32 s96, s96, 1024
  buffer_load_dwordx4 v18, s[20:23], s97 offen nt lds
  s_add_u32 s97, s97, 65536
  s_mov_b32 m0, s96
  s_add_u32 s96, s96, 1024
  buffer_load_dwordx4 v19, s[20:23], s97 offen nt lds
  s_add_u32 s97, s97, 65536
  s_mov_b32 m0, s96
  s_add_u32 s96, s96, 1024
  buffer_load_dwordx4 v18, s[20:23], s97 offen nt lds
  s_add_u32 s97, s97, 65536
  s_mov_b32 m0, s96
  s_add_u32 s96, s96, 1024
  buffer_load_dwordx4 v19, s[20:23], s97 offen nt lds
  s_add_u32 s97, s97, 65536
  s_barrier
  s_mov_b32 s8, s66
  s_and_b32 s9, s67, 0xffff
  s_mov_b32 s10, 1048576
  s_mov_b32 s11, 0x20000
  s_cmp_ge_u32 s5, 14
  s_cselect_b32 s74, 1, 0
  s_cmp_ge_u32 s5, 28
  s_cselect_b32 s74, 2, s74
  s_cmp_ge_u32 s5, 7
  s_cselect_b32 s68, 1, 0
  s_lshl_b32 s75, s4, 1
  s_add_u32 s75, s75, s68
  s_mul_i32 s68, s68, 7
  s_sub_u32 s76, s5, s68
  s_mul_i32 s77, s4, 14
  s_add_u32 s77, s77, s5
  s_sub_u32 s77, s77, 14
  s_sub_u32 s78, s5, 28
  s_lshl_b32 s78, s78, 3
  s_add_u32 s78, s78, s4
  s_and_b32 s68, s4, 3
  s_mul_i32 s69, s68, 28
  s_add_u32 s69, s69, s5
  s_mov_b32 s77, s69
  s_mul_i32 s75, s69, 9363
  s_lshr_b32 s75, s75, 16
  s_mul_i32 s70, s75, 7
  s_sub_u32 s76, s69, s70
  s_sub_u32 s78, s5, 28
  s_lshl_b32 s78, s78, 3
  s_add_u32 s78, s78, s4
  s_cmp_ge_u32 s4, 4
  s_cselect_b32 s74, 1, 0
  s_cmp_ge_u32 s5, 28
  s_cselect_b32 s74, 2, s74
  v_bfe_u32 v4, v12, 1, 1
  v_and_b32 v5, 1, v3
  v_lshl_or_b32 v4, v5, 1, v4
  v_lshlrev_b32 v4, 5, v4
  v_lshl_add_u32 v4, v13, 3, v4
  v_lshl_add_u32 v5, v3, 3, v12
  v_lshl_add_u32 v4, v5, 7, v4
  v_add_u32 v4, 131072, v4
  v_mov_b32 v52, v4
  v_xor_b32 v53, 32, v52
  v_xor_b32 v54, 64, v52
  v_xor_b32 v55, 96, v52
  v_bfe_u32 v4, v12, 1, 1
  v_lshrrev_b32 v5, 1, v3
  v_lshl_or_b32 v4, v5, 1, v4
  v_lshlrev_b32 v4, 5, v4
  v_lshl_add_u32 v4, v13, 3, v4
  v_lshl_add_u32 v5, v3, 2, v12
  v_lshl_add_u32 v4, v5, 7, v4
  v_add_u32 v56, 143360, v4
  v_xor_b32 v57, 32, v56
  v_xor_b32 v58, 64, v56
  v_xor_b32 v59, 96, v56
  v_add_u32 v62, 147456, v16
  s_add_u32 s99, s99, 147456
  v_lshlrev_b32 v60, 4, v3
  v_add_u32 v60, s99, v60
  v_lshlrev_b32 v61, 3, v3
  v_add_u32 v61, s99, v61
  v_cmp_gt_u32 s[80:81], 56, v1
  s_waitcnt vmcnt(14)
  v_lshlrev_b32 v36, 16, v32
  v_and_b32 v37, 0xffff0000, v32
  v_lshlrev_b32 v38, 16, v33
  v_and_b32 v39, 0xffff0000, v33
  v_lshlrev_b32 v40, 16, v34
  v_and_b32 v41, 0xffff0000, v34
  v_lshlrev_b32 v42, 16, v35
  v_and_b32 v43, 0xffff0000, v35
  v_add_f32 v44, v36, v37
  v_add_f32 v45, v38, v39
  v_add_f32 v46, v40, v41
  v_add_f32 v47, v42, v43
  v_add_f32 v44, v44, v45
  v_add_f32 v46, v46, v47
  v_add_f32 v44, v44, v46
  s_nop 1
  v_add_f32_dpp v44, v44, v44 row_ror:8 row_mask:0xf bank_mask:0xf
  s_nop 1
  v_add_f32_dpp v44, v44, v44 row_ror:4 row_mask:0xf bank_mask:0xf
  s_nop 1
  v_add_f32_dpp v44, v44, v44 row_ror:2 row_mask:0xf bank_mask:0xf
  s_nop 1
  v_add_f32_dpp v44, v44, v44 row_ror:1 row_mask:0xf bank_mask:0xf
  v_mov_b32 v46, v44
  s_nop 1
  v_permlane16_swap_b32 v44, v46
  v_add_f32 v44, v44, v46
  v_mov_b32 v46, v44
  s_nop 1
  v_permlane32_swap_b32 v44, v46
  v_add_f32 v44, v44, v46
  v_mul_f32 v47, 0x3b124925, v44
  v_sub_f32 v64, v36, v47
  v_sub_f32 v65, v37, v47
  v_sub_f32 v66, v38, v47
  v_sub_f32 v67, v39, v47
  v_sub_f32 v68, v40, v47
  v_sub_f32 v69, v41, v47
  v_sub_f32 v70, v42, v47
  v_sub_f32 v71, v43, v47
  v_mul_f32 v45, v64, v64
  v_mul_f32 v44, v65, v65
  v_fmac_f32 v45, v66, v66
  v_fmac_f32 v44, v67, v67
  v_fmac_f32 v45, v68, v68
  v_fmac_f32 v44, v69, v69
  v_fmac_f32 v45, v70, v70
  v_fmac_f32 v44, v71, v71
  v_add_f32 v45, v45, v44
  v_cndmask_b32 v45, 0, v45, s[80:81]
  v_cvt_pk_bf16_f32 v47, v47, v47
  v_lshlrev_b32 v47, 16, v47
  v_add_f32_dpp v45, v45, v45 row_ror:8 row_mask:0xf bank_mask:0xf
  s_nop 1
  v_add_f32_dpp v45, v45, v45 row_ror:4 row_mask:0xf bank_mask:0xf
  s_nop 1
  v_add_f32_dpp v45, v45, v45 row_ror:2 row_mask:0xf bank_mask:0xf
  s_nop 1
  v_add_f32_dpp v45, v45, v45 row_ror:1 row_mask:0xf bank_mask:0xf
  v_mov_b32 v46, v45
  s_nop 1
  v_permlane16_swap_b32 v45, v46
  v_add_f32 v45, v45, v46
  v_mov_b32 v46, v45
  s_nop 1
  v_permlane32_swap_b32 v45, v46
  v_add_f32 v45, v45, v46
  v_sub_f32 v64, v36, v47
  v_sub_f32 v65, v37, v47
  v_sub_f32 v66, v38, v47
  v_sub_f32 v67, v39, v47
  v_sub_f32 v68, v40, v47
  v_sub_f32 v69, v41, v47
  v_sub_f32 v70, v42, v47
  v_sub_f32 v71, v43, v47
  v_mul_f32 v45, 0x3b124925, v45
  v_cvt_pk_bf16_f32 v45, v45, v45
  v_lshlrev_b32 v45, 16, v45
  v_add_f32 v45, 0x3727c5ac, v45
  v_cvt_pk_bf16_f32 v45, v45, v45
  v_lshlrev_b32 v45, 16, v45
  v_sqrt_f32 v45, v45
  v_cvt_pk_bf16_f32 v32, v64, v65
  v_cvt_pk_bf16_f32 v33, v66, v67
  v_cvt_pk_bf16_f32 v34, v68, v69
  v_cvt_pk_bf16_f32 v35, v70, v71
  v_cvt_pk_bf16_f32 v45, v45, v45
  v_lshlrev_b32 v45, 16, v45
  v_rcp_f32 v45, v45
  v_lshlrev_b32 v64, 16, v32
  v_and_b32 v65, 0xffff0000, v32
  v_lshlrev_b32 v66, 16, v33
  v_and_b32 v67, 0xffff0000, v33
  v_lshlrev_b32 v68, 16, v34
  v_and_b32 v69, 0xffff0000, v34
  v_lshlrev_b32 v70, 16, v35
  v_and_b32 v71, 0xffff0000, v35
  v_mul_f32 v64, v64, v45
  v_mul_f32 v65, v65, v45
  v_mul_f32 v66, v66, v45
  v_mul_f32 v67, v67, v45
  v_mul_f32 v68, v68, v45
  v_mul_f32 v69, v69, v45
  v_mul_f32 v70, v70, v45
  v_mul_f32 v71, v71, v45
  v_cvt_pk_bf16_f32 v32, v64, v65
  v_cvt_pk_bf16_f32 v33, v66, v67
  v_cvt_pk_bf16_f32 v34, v68, v69
  v_cvt_pk_bf16_f32 v35, v70, v71
  ds_write_b128 v62, v[32:35]
  s_waitcnt lgkmcnt(0)
  ds_read_b128 v[36:39], v60 offset:0
  ds_read_b128 v[40:43], v60 offset:64
  ds_read_b128 v[44:47], v60 offset:128
  ds_read_b64 v[48:49], v61 offset:192
  s_waitcnt vmcnt(0)
  ds_read_b64_tr_b16 v[64:65], v52 offset:0
  ds_read_b64_tr_b16 v[66:67], v52 offset:512
  ds_read_b64_tr_b16 v[68:69], v52 offset:4096
  ds_read_b64_tr_b16 v[70:71], v52 offset:4608
  ds_read_b64_tr_b16 v[72:73], v52 offset:8192
  ds_read_b64_tr_b16 v[74:75], v52 offset:8704
  ds_read_b64_tr_b16 v[76:77], v56
  ds_read_b64_tr_b16 v[80:81], v53 offset:0
  ds_read_b64_tr_b16 v[82:83], v53 offset:512
  ds_read_b64_tr_b16 v[84:85], v53 offset:4096
  ds_read_b64_tr_b16 v[86:87], v53 offset:4608
  ds_read_b64_tr_b16 v[88:89], v53 offset:8192
  ds_read_b64_tr_b16 v[90:91], v53 offset:8704
  ds_read_b64_tr_b16 v[92:93], v57
  ds_read_b64_tr_b16 v[96:97], v54 offset:0
  ds_read_b64_tr_b16 v[98:99], v54 offset:512
  ds_read_b64_tr_b16 v[100:101], v54 offset:4096
  ds_read_b64_tr_b16 v[102:103], v54 offset:4608
  ds_read_b64_tr_b16 v[104:105], v54 offset:8192
  ds_read_b64_tr_b16 v[106:107], v54 offset:8704
  ds_read_b64_tr_b16 v[108:109], v58
  ds_read_b64_tr_b16 v[112:113], v55 offset:0
  ds_read_b64_tr_b16 v[114:115], v55 offset:512
  ds_read_b64_tr_b16 v[116:117], v55 offset:4096
  ds_read_b64_tr_b16 v[118:119], v55 offset:4608
  ds_read_b64_tr_b16 v[120:121], v55 offset:8192
  ds_read_b64_tr_b16 v[122:123], v55 offset:8704
  ds_read_b64_tr_b16 v[124:125], v59
  s_waitcnt lgkmcnt(15)
  v_mfma_f32_16x16x32_bf16 v[128:131], v[36:39], v[64:67], 0
  v_mfma_f32_16x16x16_bf16 v[132:135], v[48:49], v[76:77], 0
  v_mfma_f32_16x16x32_bf16 v[128:131], v[40:43], v[68:71], v[128:131]
  v_mfma_f32_16x16x32_bf16 v[128:131], v[44:47], v[72:75], v[128:131]
  s_waitcnt lgkmcnt(14)
  v_mfma_f32_16x16x32_bf16 v[136:139], v[36:39], v[80:83], 0
  v_mfma_f32_16x16x16_bf16 v[140:143], v[48:49], v[92:93], 0
  v_mfma_f32_16x16x32_bf16 v[136:139], v[40:43], v[84:87], v[136:139]
  v_mfma_f32_16x16x32_bf16 v[136:139], v[44:47], v[88:91], v[136:139]
  s_waitcnt lgkmcnt(7)
  v_mfma_f32_16x16x32_bf16 v[144:147], v[36:39], v[96:99], 0
  v_mfma_f32_16x16x16_bf16 v[148:151], v[48:49], v[108:109], 0
  v_mfma_f32_16x16x32_bf16 v[144:147], v[40:43], v[100:103], v[144:147]
  v_mfma_f32_16x16x32_bf16 v[144:147], v[44:47], v[104:107], v[144:147]
  s_waitcnt lgkmcnt(0)
  v_mfma_f32_16x16x32_bf16 v[152:155], v[36:39], v[112:115], 0
  v_mfma_f32_16x16x16_bf16 v[156:159], v[48:49], v[124:125], 0
  v_mfma_f32_16x16x32_bf16 v[152:155], v[40:43], v[116:119], v[152:155]
  v_mfma_f32_16x16x32_bf16 v[152:155], v[44:47], v[120:123], v[152:155]
  v_cmp_eq_u32 s[80:81], 1, v3
  v_cmp_eq_u32 s[82:83], 2, v3
  v_cmp_eq_u32 s[84:85], 3, v3
  s_waitcnt lgkmcnt(0)
  s_mul_i32 s6, s6, 1664525
  s_add_u32 s6, s6, 1013904223
  v_lshlrev_b32 v4, 2, v1
  v_mov_b32 v7, s6
  v_and_b32 v8, 3, v1
  v_lshlrev_b32 v8, 3, v8
  v_lshrrev_b32 v8, v8, v7
  v_and_b32 v8, 0xff, v8
  s_mov_b32 s69, 0xffffff00
  v_add_f32 v128, v128, v132
  v_add_f32 v136, v136, v140
  v_add_f32 v144, v144, v148
  v_add_f32 v152, v152, v156
  v_cndmask_b32 v6, v128, v136, s[80:81]
  v_cndmask_b32 v6, v6, v144, s[82:83]
  v_cndmask_b32 v6, v6, v152, s[84:85]
  v_and_or_b32 v6, v6, s69, v8
  v_mov_b32 v10, 153612
  s_mov_b32 s72, 200000
L_fw1_r:
  ds_read_b32 v16, v10
  s_waitcnt lgkmcnt(0)
  v_readfirstlane_b32 s73, v16
  s_nop 0
  s_cmp_eq_u32 s73, 1
  s_cbranch_scc1 L_fw1_d
  s_sub_u32 s72, s72, 1
  s_cbranch_scc0 L_fw1_r
L_fw1_d:
  buffer_store_dword v6, v4, s[8:11], s98 offen sc1
  s_lshl_b32 s68, s4, 5
  s_add_u32 s68, s68, s5
  s_lshl_b32 s68, s68, 2
  s_add_u32 s68, s68, 4096
  v_mov_b32 v5, 2147483632
  v_cmp_eq_u32 vcc, 0, v1
  s_nop 1
  v_cndmask_b32 v5, v5, 0, vcc
  buffer_store_dword v7, v5, s[8:11], s68 offen sc1
  v_lshlrev_b32 v32, 4, v1
  s_lshl_b32 s96, s4, 11
  s_add_u32 s96, s96, 8192
  v_lshlrev_b32 v33, 3, v1
  v_add_u32 v33, 148480, v33
  v_mov_b32 v10, 153600
  s_mov_b32 s72, 200000
L_fw2_r:
  ds_read_b32 v16, v10
  s_waitcnt lgkmcnt(0)
  v_readfirstlane_b32 s73, v16
  s_nop 0
  s_cmp_eq_u32 s73, 1
  s_cbranch_scc1 L_fw2_d
  s_sub_u32 s72, s72, 1
  s_cbranch_scc0 L_fw2_r
L_fw2_d:
  s_add_u32 s70, s96, 0
  buffer_load_dwordx4 v[64:67], v32, s[8:11], s70 offen sc1
  s_add_u32 s70, s96, 16384
  buffer_load_dwordx4 v[68:71], v32, s[8:11], s70 offen sc1
  s_add_u32 s70, s96, 32768
  buffer_load_dwordx4 v[72:75], v32, s[8:11], s70 offen sc1
  s_add_u32 s70, s96, 49152
  buffer_load_dwordx4 v[76:79], v32, s[8:11], s70 offen sc1
  s_add_u32 s70, s96, 1024
  buffer_load_dwordx4 v[80:83], v32, s[8:11], s70 offen sc1
  s_add_u32 s70, s96, 17408
  buffer_load_dwordx4 v[84:87], v32, s[8:11], s70 offen sc1
  s_add_u32 s70, s96, 33792
  buffer_load_dwordx4 v[88:91], v32, s[8:11], s70 offen sc1
  s_add_u32 s70, s96, 50176
  buffer_load_dwordx4 v[92:95], v32, s[8:11], s70 offen sc1
  v_mov_b32 v10, 153608
  v_mov_b32 v11, 1
  ds_write_b32 v10, v11
  s_branch L_h1_wait
L_h1_retry:
  s_add_u32 s70, s96, 0
  buffer_load_dwordx4 v[64:67], v32, s[8:11], s70 offen sc1
  s_add_u32 s70, s96, 16384
  buffer_load_dwordx4 v[68:71], v32, s[8:11], s70 offen sc1
  s_add_u32 s70, s96, 32768
  buffer_load_dwordx4 v[72:75], v32, s[8:11], s70 offen sc1
  s_add_u32 s70, s96, 49152
  buffer_load_dwordx4 v[76:79], v32, s[8:11], s70 offen sc1
  s_add_u32 s70, s96, 1024
  buffer_load_dwordx4 v[80:83], v32, s[8:11], s70 offen sc1
  s_add_u32 s70, s96, 17408
  buffer_load_dwordx4 v[84:87], v32, s[8:11], s70 offen sc1
  s_add_u32 s70, s96, 33792
  buffer_load_dwordx4 v[88:91], v32, s[8:11], s70 offen sc1
  s_add_u32 s70, s96, 50176
  buffer_load_dwordx4 v[92:95], v32, s[8:11], s70 offen sc1
L_h1_wait:
  s_mov_b32 s68, 0x0c0c0400
  s_mov_b32 s69, 0x04000c0c
  s_waitcnt vmcnt(0)
  v_perm_b32 v37, v65, v64, s68
  v_perm_b32 v38, v67, v66, s69
  v_or_b32 v37, v37, v38
  v_xor_b32 v36, s6, v37
  v_perm_b32 v37, v69, v68, s68
  v_perm_b32 v38, v71, v70, s69
  v_or_b32 v37, v37, v38
  v_xor_b32 v37, s6, v37
  v_or_b32 v36, v36, v37
  v_perm_b32 v37, v73, v72, s68
  v_perm_b32 v38, v75, v74, s69
  v_or_b32 v37, v37, v38
  v_xor_b32 v37, s6, v37
  v_or_b32 v36, v36, v37
  v_perm_b32 v37, v77, v76, s68
  v_perm_b32 v38, v79, v78, s69
  v_or_b32 v37, v37, v38
  v_xor_b32 v37, s6, v37
  v_or_b32 v36, v36, v37
  v_perm_b32 v37, v81, v80, s68
  v_perm_b32 v38, v83, v82, s69
  v_or_b32 v37, v37, v38
  v_xor_b32 v37, s6, v37
  v_or_b32 v36, v36, v37
  v_perm_b32 v37, v85, v84, s68
  v_perm_b32 v38, v87, v86, s69
  v_or_b32 v37, v37, v38
  v_xor_b32 v37, s6, v37
  v_or_b32 v36, v36, v37
  v_perm_b32 v37, v89, v88, s68
  v_perm_b32 v38, v91, v90, s69
  v_or_b32 v37, v37, v38
  v_xor_b32 v37, s6, v37
  v_or_b32 v36, v36, v37
  v_perm_b32 v37, v93, v92, s68
  v_perm_b32 v38, v95, v94, s69
  v_or_b32 v37, v37, v38
  v_xor_b32 v37, s6, v37
  v_or_b32 v36, v36, v37
  v_cmp_ne_u32 vcc, 0, v36
  s_nop 0
  s_and_b64 vcc, exec, vcc
  s_cbranch_vccz L_h1_ok
  s_sub_u32 s7, s7, 1
  s_cbranch_scc0 L_h1_retry
L_h1_ok:
  v_and_b32 v64, 0xffffff00, v64
  v_and_b32 v65, 0xffffff00, v65
  v_and_b32 v66, 0xffffff00, v66
  v_and_b32 v67, 0xffffff00, v67
  v_and_b32 v68, 0xffffff00, v68
  v_and_b32 v69, 0xffffff00, v69
  v_and_b32 v70, 0xffffff00, v70
  v_and_b32 v71, 0xffffff00, v71
  v_and_b32 v72, 0xffffff00, v72
  v_and_b32 v73, 0xffffff00, v73
  v_and_b32 v74, 0xffffff00, v74
  v_and_b32 v75, 0xffffff00, v75
  v_and_b32 v76, 0xffffff00, v76
  v_and_b32 v77, 0xffffff00, v77
  v_and_b32 v78, 0xffffff00, v78
  v_and_b32 v79, 0xffffff00, v79
  v_and_b32 v80, 0xffffff00, v80
  v_and_b32 v81, 0xffffff00, v81
  v_and_b32 v82, 0xffffff00, v82
  v_and_b32 v83, 0xffffff00, v83
  v_and_b32 v84, 0xffffff00, v84
  v_and_b32 v85, 0xffffff00, v85
  v_and_b32 v86, 0xffffff00, v86
  v_and_b32 v87, 0xffffff00, v87
  v_and_b32 v88, 0xffffff00, v88
  v_and_b32 v89, 0xffffff00, v89
  v_and_b32 v90, 0xffffff00, v90
  v_and_b32 v91, 0xffffff00, v91
  v_and_b32 v92, 0xffffff00, v92
  v_and_b32 v93, 0xffffff00, v93
  v_and_b32 v94, 0xffffff00, v94
  v_and_b32 v95, 0xffffff00, v95
  v_add_f32 v64, v64, v68
  v_add_f32 v72, v72, v76
  v_add_f32 v65, v65, v69
  v_add_f32 v73, v73, v77
  v_add_f32 v66, v66, v70
  v_add_f32 v74, v74, v78
  v_add_f32 v67, v67, v71
  v_add_f32 v75, v75, v79
  v_add_f32 v64, v64, v72
  v_add_f32 v65, v65, v73
  v_add_f32 v66, v66, v74
  v_add_f32 v67, v67, v75
  v_cvt_pk_bf16_f32 v64, v64, v65
  v_cvt_pk_bf16_f32 v65, v66, v67
  ds_write_b64 v33, v[64:65] offset:0
  v_add_f32 v80, v80, v84
  v_add_f32 v88, v88, v92
  v_add_f32 v81, v81, v85
  v_add_f32 v89, v89, v93
  v_add_f32 v82, v82, v86
  v_add_f32 v90, v90, v94
  v_add_f32 v83, v83, v87
  v_add_f32 v91, v91, v95
  v_add_f32 v80, v80, v88
  v_add_f32 v81, v81, v89
  v_add_f32 v82, v82, v90
  v_add_f32 v83, v83, v91
  v_cvt_pk_bf16_f32 v80, v80, v81
  v_cvt_pk_bf16_f32 v81, v82, v83
  ds_write_b64 v33, v[80:81] offset:512
  v_mov_b32 v10, 153604
  v_mov_b32 v11, 1
  ds_write_b32 v10, v11
  s_setprio 0
  s_branch L_T_roles
L_A2:
  v_and_b32 v4, 3, v2
  v_xor_b32 v4, v3, v4
  v_lshrrev_b32 v5, 2, v2
  v_lshl_or_b32 v4, v5, 2, v4
  v_lshlrev_b32 v4, 4, v4
  v_lshl_add_u32 v4, v2, 9, v4
  v_add_u32 v32, s99, v4
  v_xor_b32 v33, 64, v32
  v_xor_b32 v34, 128, v32
  v_xor_b32 v35, 192, v32
  v_bfe_u32 v4, v12, 1, 1
  v_and_b32 v5, 1, v3
  v_lshl_or_b32 v4, v5, 1, v4
  v_lshlrev_b32 v4, 5, v4
  v_lshl_add_u32 v4, v13, 3, v4
  v_lshl_add_u32 v5, v3, 3, v12
  v_lshl_add_u32 v4, v5, 7, v4
  v_add_u32 v36, s98, v4
  v_xor_b32 v37, 32, v36
  v_xor_b32 v38, 64, v36
  v_xor_b32 v39, 96, v36
  v_and_b32 v4, 1, v2
  v_lshlrev_b32 v5, 9, v4
  v_lshl_add_u32 v5, v3, 4, v5
  v_add_u32 v40, 148480, v5
  v_lshlrev_b32 v5, 2, v1
  v_add_u32 v42, 150016, v5
  s_lshl_b32 s68, s3, 8
  v_add_u32 v41, s68, v42
  v_lshlrev_b32 v4, 8, v4
  v_add_u32 v4, 149504, v4
  s_lshl_b32 s68, s3, 2
  v_lshl_add_u32 v43, v3, 5, v4
  v_add_u32 v43, s68, v43
  v_lshl_add_u32 v44, v3, 4, v4
  s_lshr_b32 s68, s3, 1
  s_lshl_b32 s68, s68, 4
  s_add_u32 s68, s68, 153600
  v_mov_b32 v47, s68
  v_bfe_u32 v4, v2, 1, 2
  v_cmp_eq_u32 s[80:81], 1, v4
  v_cmp_eq_u32 s[82:83], 2, v4
  v_cmp_eq_u32 s[84:85], 3, v4
  v_and_b32 v5, 1, v2
  v_lshlrev_b32 v5, 14, v5
  v_lshrrev_b32 v6, 1, v4
  v_lshl_add_u32 v5, v6, 11, v5
  v_and_b32 v6, 1, v4
  v_lshl_add_u32 v5, v6, 5, v5
  v_lshl_add_u32 v5, v3, 3, v5
  s_lshl_b32 s68, s4, 15
  s_lshl_b32 s69, s3, 12
  s_add_u32 s68, s68, s69
  s_lshl_b32 s69, s5, 6
  s_add_u32 s68, s68, s69
  s_add_u32 s68, s68, 262144
  v_add_u32 v5, s68, v5
  v_mov_b32 v9, 2147483632
  v_cmp_gt_u32 vcc, 8, v2
  s_nop 1
  v_cndmask_b32 v45, v9, v5, vcc
  s_lshl_b32 s68, s4, 10
  s_lshl_b32 s69, s5, 4
  s_add_u32 s68, s68, s69
  s_add_u32 s68, s68, 524288
  v_lshlrev_b32 v4, 9, v1
  v_add_u32 v4, s68, v4
  s_cmp_eq_u32 s3, 0
  s_cselect_b32 s68, 2, 0
  v_mov_b32 v9, 2147483632
  v_cmp_gt_u32 vcc, s68, v1
  s_nop 1
  v_cndmask_b32 v46, v9, v4, vcc
  s_mov_b32 s8, s66
  s_and_b32 s9, s67, 0xffff
  s_mov_b32 s10, 1048576
  s_mov_b32 s11, 0x20000
  s_waitcnt vmcnt(7)
  s_mov_b32 m0, s96
  s_add_u32 s96, s96, 1024
  buffer_load_dwordx4 v20, s[12:15], s97 offen nt lds
  s_add_u32 s97, s97, 4096
  s_waitcnt vmcnt(7)
  s_mov_b32 m0, s96
  s_add_u32 s96, s96, 1024
  buffer_load_dwordx4 v21, s[12:15], s97 offen nt lds
  s_add_u32 s97, s97, 4096
  s_waitcnt vmcnt(7)
  s_mov_b32 m0, s96
  s_add_u32 s96, s96, 1024
  buffer_load_dwordx4 v22, s[12:15], s97 offen nt lds
  s_add_u32 s97, s97, 4096
  s_waitcnt vmcnt(7)
  s_mov_b32 m0, s96
  s_add_u32 s96, s96, 1024
  buffer_load_dwordx4 v23, s[12:15], s97 offen nt lds
  s_add_u32 s97, s97, 4096
  s_waitcnt vmcnt(7)
  s_mov_b32 m0, s96
  s_add_u32 s96, s96, 1024
  buffer_load_dwordx4 v24, s[12:15], s97 offen nt lds
  s_add_u32 s97, s97, 4096
  s_waitcnt vmcnt(7)
  s_mov_b32 m0, s96
  s_add_u32 s96, s96, 1024
  buffer_load_dwordx4 v25, s[12:15], s97 offen nt lds
  s_add_u32 s97, s97, 4096
  s_waitcnt vmcnt(7)
  s_mov_b32 m0, s96
  s_add_u32 s96, s96, 1024
  buffer_load_dwordx4 v26, s[12:15], s97 offen nt lds
  s_add_u32 s97, s97, 4096
  s_waitcnt vmcnt(7)
  s_mov_b32 m0, s96
  s_add_u32 s96, s96, 1024
  buffer_load_dwordx4 v27, s[12:15], s97 offen nt lds
  s_add_u32 s97, s97, 4096
  s_lshl_b32 s73, s3, 2
  s_add_u32 s73, s73, 153616
  v_mov_b32 v10, s73
  v_mov_b32 v11, 1
  ds_write_b32 v10, v11
  s_cmp_lg_u32 s3, 0
  s_cbranch_scc1 L_fl3
  s_waitcnt vmcnt(6)
  v_mov_b32 v10, 153600
  v_mov_b32 v11, 1
  ds_write_b32 v10, v11
L_fl3:
  s_waitcnt vmcnt(0)
  ds_read_b128 v[64:67], v32 offset:0
  ds_read_b128 v[68:71], v33 offset:0
  ds_read_b128 v[72:75], v34 offset:0
  ds_read_b128 v[76:79], v35 offset:0
  ds_read_b128 v[80:83], v32 offset:256
  ds_read_b128 v[84:87], v33 offset:256
  ds_read_b128 v[88:91], v34 offset:256
  ds_read_b128 v[92:95], v35 offset:256
  ds_read_b128 v[96:99], v32 offset:8192
  ds_read_b128 v[100:103], v33 offset:8192
  ds_read_b128 v[104:107], v34 offset:8192
  ds_read_b128 v[108:111], v35 offset:8192
  ds_read_b128 v[112:115], v32 offset:8448
  ds_read_b128 v[116:119], v33 offset:8448
  ds_read_b128 v[120:123], v34 offset:8448
  ds_read_b128 v[124:127], v35 offset:8448
  s_waitcnt lgkmcnt(0)
  s_lshl_b32 s73, s3, 2
  s_add_u32 s73, s73, 153632
  v_mov_b32 v10, s73
  v_mov_b32 v11, 1
  ds_write_b32 v10, v11
  v_mov_b32 v10, 153604
  s_mov_b32 s72, 200000
L_fw4_r:
  ds_read_b32 v16, v10
  s_waitcnt lgkmcnt(0)
  v_readfirstlane_b32 s73, v16
  s_nop 0
  s_cmp_eq_u32 s73, 1
  s_cbranch_scc1 L_fw4_d
  s_sub_u32 s72, s72, 1
  s_cbranch_scc0 L_fw4_r
L_fw4_d:
  ds_read_b128 v[128:131], v40 offset:0
  ds_read_b128 v[132:135], v40 offset:64
  ds_read_b128 v[136:139], v40 offset:128
  ds_read_b128 v[140:143], v40 offset:192
  ds_read_b128 v[144:147], v40 offset:256
  ds_read_b128 v[148:151], v40 offset:320
  ds_read_b128 v[152:155], v40 offset:384
  ds_read_b128 v[156:159], v40 offset:448
  s_waitcnt lgkmcnt(7)
  v_mfma_f32_16x16x32_bf16 v[160:163], v[64:67], v[128:131], 0
  v_mfma_f32_16x16x32_bf16 v[164:167], v[96:99], v[128:131], 0
  s_waitcnt lgkmcnt(6)
  v_mfma_f32_16x16x32_bf16 v[160:163], v[68:71], v[132:135], v[160:163]
  v_mfma_f32_16x16x32_bf16 v[164:167], v[100:103], v[132:135], v[164:167]
  s_waitcnt lgkmcnt(5)
  v_mfma_f32_16x16x32_bf16 v[160:163], v[72:75], v[136:139], v[160:163]
  v_mfma_f32_16x16x32_bf16 v[164:167], v[104:107], v[136:139], v[164:167]
  s_waitcnt lgkmcnt(4)
  v_mfma_f32_16x16x32_bf16 v[160:163], v[76:79], v[140:143], v[160:163]
  v_mfma_f32_16x16x32_bf16 v[164:167], v[108:111], v[140:143], v[164:167]
  s_waitcnt lgkmcnt(3)
  v_mfma_f32_16x16x32_bf16 v[160:163], v[80:83], v[144:147], v[160:163]
  v_mfma_f32_16x16x32_bf16 v[164:167], v[112:115], v[144:147], v[164:167]
  s_waitcnt lgkmcnt(2)
  v_mfma_f32_16x16x32_bf16 v[160:163], v[84:87], v[148:151], v[160:163]
  v_mfma_f32_16x16x32_bf16 v[164:167], v[116:119], v[148:151], v[164:167]
  s_waitcnt lgkmcnt(1)
  v_mfma_f32_16x16x32_bf16 v[160:163], v[88:91], v[152:155], v[160:163]
  v_mfma_f32_16x16x32_bf16 v[164:167], v[120:123], v[152:155], v[164:167]
  s_waitcnt lgkmcnt(0)
  v_mfma_f32_16x16x32_bf16 v[160:163], v[92:95], v[156:159], v[160:163]
  v_mfma_f32_16x16x32_bf16 v[164:167], v[124:127], v[156:159], v[164:167]
  s_nop 6
  v_cvt_pk_bf16_f32 v168, v160, v161
  v_cvt_pk_bf16_f32 v169, v162, v163
  v_cvt_pk_bf16_f32 v170, v164, v165
  v_cvt_pk_bf16_f32 v171, v166, v167
  v_lshlrev_b32 v172, 16, v168
  v_and_b32 v173, 0xffff0000, v168
  v_lshlrev_b32 v174, 16, v169
  v_and_b32 v175, 0xffff0000, v169
  v_lshlrev_b32 v176, 16, v170
  v_and_b32 v177, 0xffff0000, v170
  v_lshlrev_b32 v178, 16, v171
  v_and_b32 v179, 0xffff0000, v171
  v_max3_f32 v180, v172, v173, v174
  v_max3_f32 v181, v175, v176, v177
  v_max3_f32 v180, v180, v178, v179
  v_max_f32 v180, v180, v181
  v_mov_b32 v181, v180
  s_nop 1
  v_permlane16_swap_b32 v180, v181
  v_max_f32 v180, v180, v181
  v_mov_b32 v181, v180
  s_nop 1
  v_permlane32_swap_b32 v180, v181
  v_max_f32 v180, v180, v181
  ds_write_b32 v41, v180
  s_mov_b32 s68, 0x3db8aa3b
  s_lshl_b32 s73, s3, 2
  s_add_u32 s73, s73, 153648
  v_mov_b32 v10, s73
  v_mov_b32 v11, 1
  ds_write_b32 v10, v11
  v_mov_b32 v10, 153648
  s_mov_b32 s72, 200000
L_fw5_r:
  ds_read_b128 v[16:19], v10
  s_waitcnt lgkmcnt(0)
  v_and_b32 v16, v16, v17
  v_and_b32 v18, v18, v19
  v_and_b32 v16, v16, v18
  s_nop 0
  v_readfirstlane_b32 s73, v16
  s_nop 0
  s_cmp_eq_u32 s73, 1
  s_cbranch_scc1 L_fw5_d
  s_sub_u32 s72, s72, 1
  s_cbranch_scc0 L_fw5_r
L_fw5_d:
  ds_read_b32 v4, v42 offset:0
  ds_read_b32 v5, v42 offset:256
  ds_read_b32 v6, v42 offset:512
  ds_read_b32 v7, v42 offset:768
  s_waitcnt lgkmcnt(0)
  v_max3_f32 v180, v4, v5, v6
  v_max_f32 v180, v180, v7
  v_mul_f32 v180, s68, v180
  v_fma_f32 v172, v172, s68, -v180
  v_fma_f32 v173, v173, s68, -v180
  v_fma_f32 v174, v174, s68, -v180
  v_fma_f32 v175, v175, s68, -v180
  v_fma_f32 v176, v176, s68, -v180
  v_fma_f32 v177, v177, s68, -v180
  v_fma_f32 v178, v178, s68, -v180
  v_fma_f32 v179, v179, s68, -v180
  v_exp_f32 v172, v172
  v_exp_f32 v173, v173
  v_exp_f32 v174, v174
  v_exp_f32 v175, v175
  v_exp_f32 v176, v176
  v_exp_f32 v177, v177
  v_exp_f32 v178, v178
  v_exp_f32 v179, v179
  v_cvt_pk_bf16_f32 v168, v172, v173
  v_cvt_pk_bf16_f32 v169, v174, v175
  v_cvt_pk_bf16_f32 v170, v176, v177
  v_cvt_pk_bf16_f32 v171, v178, v179
  ds_write_b32 v43, v168 offset:0
  ds_write_b32 v43, v169 offset:16
  ds_write_b32 v43, v170 offset:128
  ds_write_b32 v43, v171 offset:144
  s_lshl_b32 s73, s3, 2
  s_add_u32 s73, s73, 153664
  v_mov_b32 v10, s73
  v_mov_b32 v11, 1
  ds_write_b32 v10, v11
  v_add_f32 v172, v172, v173
  v_add_f32 v174, v174, v175
  v_add_f32 v176, v176, v177
  v_add_f32 v178, v178, v179
  v_add_f32 v172, v172, v174
  v_add_f32 v176, v176, v178
  v_add_f32 v182, v172, v176
  v_mov_b32 v181, v182
  s_nop 1
  v_permlane16_swap_b32 v182, v181
  v_add_f32 v182, v182, v181
  v_mov_b32 v181, v182
  s_nop 1
  v_permlane32_swap_b32 v182, v181
  v_add_f32 v182, v182, v181
  ds_write_b32 v41, v182 offset:1024
  s_lshl_b32 s73, s3, 2
  s_add_u32 s73, s73, 153792
  v_mov_b32 v10, s73
  v_mov_b32 v11, 1
  ds_write_b32 v10, v11
  v_mov_b32 v10, 153664
  s_mov_b32 s72, 200000
L_fw6_r:
  ds_read_b128 v[16:19], v10
  s_waitcnt lgkmcnt(0)
  v_and_b32 v16, v16, v17
  v_and_b32 v18, v18, v19
  v_and_b32 v16, v16, v18
  s_nop 0
  v_readfirstlane_b32 s73, v16
  s_nop 0
  s_cmp_eq_u32 s73, 1
  s_cbranch_scc1 L_fw6_d
  s_sub_u32 s72, s72, 1
  s_cbranch_scc0 L_fw6_r
L_fw6_d:
  ds_read_b128 v[184:187], v44 offset:0
  ds_read_b128 v[188:191], v44 offset:64
  ds_read_b128 v[192:195], v44 offset:128
  ds_read_b128 v[196:199], v44 offset:192
  s_mov_b32 s72, 200000
L_fw7_r:
  ds_read_b32 v16, v47 offset:80
  s_waitcnt lgkmcnt(0)
  v_readfirstlane_b32 s73, v16
  s_nop 0
  s_cmp_eq_u32 s73, 1
  s_cbranch_scc1 L_fw7_d
  s_sub_u32 s72, s72, 1
  s_cbranch_scc0 L_fw7_r
L_fw7_d:
  ds_read_b64_tr_b16 v[64:65], v36 offset:0
  ds_read_b64_tr_b16 v[66:67], v36 offset:512
  ds_read_b64_tr_b16 v[68:69], v37 offset:0
  ds_read_b64_tr_b16 v[70:71], v37 offset:512
  ds_read_b64_tr_b16 v[72:73], v38 offset:0
  ds_read_b64_tr_b16 v[74:75], v38 offset:512
  ds_read_b64_tr_b16 v[76:77], v39 offset:0
  ds_read_b64_tr_b16 v[78:79], v39 offset:512
  s_waitcnt lgkmcnt(6)
  v_mfma_f32_16x16x32_bf16 v[200:203], v[64:67], v[184:187], 0
  s_waitcnt lgkmcnt(4)
  v_mfma_f32_16x16x32_bf16 v[204:207], v[68:71], v[184:187], 0
  s_waitcnt lgkmcnt(2)
  v_mfma_f32_16x16x32_bf16 v[208:211], v[72:75], v[184:187], 0
  s_waitcnt lgkmcnt(0)
  v_mfma_f32_16x16x32_bf16 v[212:215], v[76:79], v[184:187], 0
  s_mov_b32 s72, 200000
L_fw8_r:
  ds_read_b32 v16, v47 offset:84
  s_waitcnt lgkmcnt(0)
  v_readfirstlane_b32 s73, v16
  s_nop 0
  s_cmp_eq_u32 s73, 1
  s_cbranch_scc1 L_fw8_d
  s_sub_u32 s72, s72, 1
  s_cbranch_scc0 L_fw8_r
L_fw8_d:
  ds_read_b64_tr_b16 v[80:81], v36 offset:4096
  ds_read_b64_tr_b16 v[82:83], v36 offset:4608
  ds_read_b64_tr_b16 v[84:85], v37 offset:4096
  ds_read_b64_tr_b16 v[86:87], v37 offset:4608
  ds_read_b64_tr_b16 v[88:89], v38 offset:4096
  ds_read_b64_tr_b16 v[90:91], v38 offset:4608
  ds_read_b64_tr_b16 v[92:93], v39 offset:4096
  ds_read_b64_tr_b16 v[94:95], v39 offset:4608
  s_waitcnt lgkmcnt(6)
  v_mfma_f32_16x16x32_bf16 v[200:203], v[80:83], v[188:191], v[200:203]
  s_waitcnt lgkmcnt(4)
  v_mfma_f32_16x16x32_bf16 v[204:207], v[84:87], v[188:191], v[204:207]
  s_waitcnt lgkmcnt(2)
  v_mfma_f32_16x16x32_bf16 v[208:211], v[88:91], v[188:191], v[208:211]
  s_waitcnt lgkmcnt(0)
  v_mfma_f32_16x16x32_bf16 v[212:215], v[92:95], v[188:191], v[212:215]
  s_cmp_lg_u32 s3, 0
  s_cbranch_scc1 L_ml9
  v_mov_b32 v10, 153792
  s_mov_b32 s72, 200000
L_fw10_r:
  ds_read_b128 v[16:19], v10
  s_waitcnt lgkmcnt(0)
  v_and_b32 v16, v16, v17
  v_and_b32 v18, v18, v19
  v_and_b32 v16, v16, v18
  s_nop 0
  v_readfirstlane_b32 s73, v16
  s_nop 0
  s_cmp_eq_u32 s73, 1
  s_cbranch_scc1 L_fw10_d
  s_sub_u32 s72, s72, 1
  s_cbranch_scc0 L_fw10_r
L_fw10_d:
  ds_read_b32 v4, v42 offset:1024
  ds_read_b32 v5, v42 offset:1280
  ds_read_b32 v6, v42 offset:1536
  ds_read_b32 v7, v42 offset:1792
  s_waitcnt lgkmcnt(0)
  v_add_f32 v4, v4, v5
  v_add_f32 v6, v6, v7
  v_add_f32 v182, v4, v6
  v_min_u32 v48, -2, v180
  v_min_u32 v49, -2, v182
  buffer_store_dwordx2 v[48:49], v46, s[8:11], 0 offen sc1
L_ml9:
  s_mov_b32 s72, 200000
L_fw11_r:
  ds_read_b32 v16, v47 offset:88
  s_waitcnt lgkmcnt(0)
  v_readfirstlane_b32 s73, v16
  s_nop 0
  s_cmp_eq_u32 s73, 1
  s_cbranch_scc1 L_fw11_d
  s_sub_u32 s72, s72, 1
  s_cbranch_scc0 L_fw11_r
L_fw11_d:
  ds_read_b64_tr_b16 v[64:65], v36 offset:8192
  ds_read_b64_tr_b16 v[66:67], v36 offset:8704
  ds_read_b64_tr_b16 v[68:69], v37 offset:8192
  ds_read_b64_tr_b16 v[70:71], v37 offset:8704
  ds_read_b64_tr_b16 v[72:73], v38 offset:8192
  ds_read_b64_tr_b16 v[74:75], v38 offset:8704
  ds_read_b64_tr_b16 v[76:77], v39 offset:8192
  ds_read_b64_tr_b16 v[78:79], v39 offset:8704
  s_waitcnt lgkmcnt(6)
  v_mfma_f32_16x16x32_bf16 v[200:203], v[64:67], v[192:195], v[200:203]
  s_waitcnt lgkmcnt(4)
  v_mfma_f32_16x16x32_bf16 v[204:207], v[68:71], v[192:195], v[204:207]
  s_waitcnt lgkmcnt(2)
  v_mfma_f32_16x16x32_bf16 v[208:211], v[72:75], v[192:195], v[208:211]
  s_waitcnt lgkmcnt(0)
  v_mfma_f32_16x16x32_bf16 v[212:215], v[76:79], v[192:195], v[212:215]
  s_mov_b32 s72, 200000
L_fw12_r:
  ds_read_b32 v16, v47 offset:92
  s_waitcnt lgkmcnt(0)
  v_readfirstlane_b32 s73, v16
  s_nop 0
  s_cmp_eq_u32 s73, 1
  s_cbranch_scc1 L_fw12_d
  s_sub_u32 s72, s72, 1
  s_cbranch_scc0 L_fw12_r
L_fw12_d:
  ds_read_b64_tr_b16 v[80:81], v36 offset:12288
  ds_read_b64_tr_b16 v[82:83], v36 offset:12800
  ds_read_b64_tr_b16 v[84:85], v37 offset:12288
  ds_read_b64_tr_b16 v[86:87], v37 offset:12800
  ds_read_b64_tr_b16 v[88:89], v38 offset:12288
  ds_read_b64_tr_b16 v[90:91], v38 offset:12800
  ds_read_b64_tr_b16 v[92:93], v39 offset:12288
  ds_read_b64_tr_b16 v[94:95], v39 offset:12800
  s_waitcnt lgkmcnt(6)
  v_mfma_f32_16x16x32_bf16 v[200:203], v[80:83], v[196:199], v[200:203]
  s_waitcnt lgkmcnt(4)
  v_mfma_f32_16x16x32_bf16 v[204:207], v[84:87], v[196:199], v[204:207]
  s_waitcnt lgkmcnt(2)
  v_mfma_f32_16x16x32_bf16 v[208:211], v[88:91], v[196:199], v[208:211]
  s_waitcnt lgkmcnt(0)
  v_mfma_f32_16x16x32_bf16 v[212:215], v[92:95], v[196:199], v[212:215]
  s_nop 1
  v_cvt_pk_bf16_f32 v48, v200, v201
  v_cvt_pk_bf16_f32 v49, v202, v203
  v_cvt_pk_bf16_f32 v50, v204, v205
  v_cvt_pk_bf16_f32 v51, v206, v207
  v_cvt_pk_bf16_f32 v52, v208, v209
  v_cvt_pk_bf16_f32 v53, v210, v211
  v_cvt_pk_bf16_f32 v54, v212, v213
  v_cvt_pk_bf16_f32 v55, v214, v215
  v_cndmask_b32 v48, v48, v50, s[80:81]
  v_cndmask_b32 v49, v49, v51, s[80:81]
  v_cndmask_b32 v48, v48, v52, s[82:83]
  v_cndmask_b32 v49, v49, v53, s[82:83]
  v_cndmask_b32 v48, v48, v54, s[84:85]
  v_cndmask_b32 v49, v49, v55, s[84:85]
  v_min_u32 v48, -2, v48
  v_min_u32 v49, -2, v49
  buffer_store_dwordx2 v[48:49], v45, s[8:11], 0 offen sc1
  s_lshl_b32 s73, s3, 2
  s_add_u32 s73, s73, 153728
  v_mov_b32 v10, s73
  v_mov_b32 v11, 1
  ds_write_b32 v10, v11
  s_waitcnt vmcnt(0)
  s_lshl_b32 s73, s3, 2
  s_add_u32 s73, s73, 153744
  v_mov_b32 v10, s73
  v_mov_b32 v11, 1
  ds_write_b32 v10, v11
  s_endpgm
L_T_idle0:
  s_cmp_eq_u32 s79, 1
  s_cbranch_scc1 L_T1_start
  s_barrier
  s_waitcnt lgkmcnt(0)
  s_load_dword s6, s[66:67], 0
  s_mov_b32 s8, s66
  s_and_b32 s9, s67, 0xffff
  s_mov_b32 s10, 1048576
  s_mov_b32 s11, 0x20000
  s_cmp_ge_u32 s5, 14
  s_cselect_b32 s74, 1, 0
  s_cmp_ge_u32 s5, 28
  s_cselect_b32 s74, 2, s74
  s_cmp_ge_u32 s5, 7
  s_cselect_b32 s68, 1, 0
  s_lshl_b32 s75, s4, 1
  s_add_u32 s75, s75, s68
  s_mul_i32 s68, s68, 7
  s_sub_u32 s76, s5, s68
  s_mul_i32 s77, s4, 14
  s_add_u32 s77, s77, s5
  s_sub_u32 s77, s77, 14
  s_sub_u32 s78, s5, 28
  s_lshl_b32 s78, s78, 3
  s_add_u32 s78, s78, s4
  s_and_b32 s68, s4, 3
  s_mul_i32 s69, s68, 28
  s_add_u32 s69, s69, s5
  s_mov_b32 s77, s69
  s_mul_i32 s75, s69, 9363
  s_lshr_b32 s75, s75, 16
  s_mul_i32 s70, s75, 7
  s_sub_u32 s76, s69, s70
  s_sub_u32 s78, s5, 28
  s_lshl_b32 s78, s78, 3
  s_add_u32 s78, s78, s4
  s_cmp_ge_u32 s4, 4
  s_cselect_b32 s74, 1, 0
  s_cmp_ge_u32 s5, 28
  s_cselect_b32 s74, 2, s74
  s_branch L_T_tag
L_T1_start:
  v_lshlrev_b32 v4, 2, v1
  v_add_u32 v4, 153600, v4
  v_mov_b32 v5, 0
  ds_write_b32 v4, v5
  s_cmp_ge_u32 s5, 14
  s_cselect_b32 s74, 1, 0
  s_cmp_ge_u32 s5, 28
  s_cselect_b32 s74, 2, s74
  s_cmp_ge_u32 s5, 7
  s_cselect_b32 s68, 1, 0
  s_lshl_b32 s75, s4, 1
  s_add_u32 s75, s75, s68
  s_mul_i32 s68, s68, 7
  s_sub_u32 s76, s5, s68
  s_mul_i32 s77, s4, 14
  s_add_u32 s77, s77, s5
  s_sub_u32 s77, s77, 14
  s_sub_u32 s78, s5, 28
  s_lshl_b32 s78, s78, 3
  s_add_u32 s78, s78, s4
  v_lshrrev_b32 v4, 2, v1
  v_and_b32 v5, 3, v1
  v_lshlrev_b32 v6, 4, v5
  v_lshl_add_u32 v20, v4, 11, v6
  s_lshl_b32 s68, s4, 15
  s_lshl_b32 s69, s5, 6
  s_add_u32 s68, s68, s69
  s_add_u32 s68, s68, 262144
  v_add_u32 v20, s68, v20
  v_mov_b32 v21, 2147483632
  v_mov_b32 v22, 2147483632
  s_lshl_b32 s68, s4, 10
  s_lshl_b32 s69, s5, 4
  s_add_u32 s68, s68, s69
  s_add_u32 s68, s68, 524288
  v_lshlrev_b32 v7, 9, v1
  v_add_u32 v7, s68, v7
  v_cmp_gt_u32 vcc, 2, v1
  s_nop 1
  v_cndmask_b32 v22, v22, v7, vcc
  s_cmp_eq_u32 s74, 2
  s_cbranch_scc1 L_clr_done
  s_cmp_eq_u32 s74, 1
  s_cbranch_scc1 L_clr_f
  s_lshl_b32 s68, s76, 11
  s_lshl_b32 s69, s75, 6
  s_add_u32 s68, s68, s69
  s_add_u32 s68, s68, 538624
  v_lshl_add_u32 v7, v4, 10, v6
  v_add_u32 v7, s68, v7
  v_lshrrev_b32 v8, 3, v1
  v_cmp_eq_u32 vcc, 1, v8
  s_nop 1
  v_cndmask_b32 v22, v22, v7, vcc
  s_branch L_clr_done
L_clr_f:
  s_lshl_b32 s68, s77, 6
  s_add_u32 s68, s68, 557056
  v_mul_u32_u24 v7, 7168, v4
  v_add_u32 v7, v7, v6
  v_add_u32 v21, s68, v7
  v_add_u32 v7, 86016, v21
  v_cmp_le_u32 vcc, 16, v1
  s_nop 1
  v_cndmask_b32 v22, v22, v7, vcc
L_clr_done:
  v_mov_b32 v28, -1
  v_mov_b32 v29, -1
  v_mov_b32 v30, -1
  v_mov_b32 v31, -1
  s_waitcnt lgkmcnt(0)
  s_load_dword s6, s[66:67], 0
  s_mov_b32 s8, s66
  s_and_b32 s9, s67, 0xffff
  s_mov_b32 s10, 1048576
  s_mov_b32 s11, 0x20000
  buffer_store_dwordx4 v[28:31], v20, s[8:11], 0 offen sc1
  buffer_store_dwordx4 v[28:31], v21, s[8:11], 0 offen sc1
  buffer_store_dwordx4 v[28:31], v22, s[8:11], 0 offen sc1
  s_barrier
  s_and_b32 s68, s4, 3
  s_mul_i32 s69, s68, 28
  s_add_u32 s69, s69, s5
  s_mov_b32 s77, s69
  s_mul_i32 s75, s69, 9363
  s_lshr_b32 s75, s75, 16
  s_mul_i32 s70, s75, 7
  s_sub_u32 s76, s69, s70
  s_sub_u32 s78, s5, 28
  s_lshl_b32 s78, s78, 3
  s_add_u32 s78, s78, s4
  s_cmp_ge_u32 s4, 4
  s_cselect_b32 s74, 1, 0
  s_cmp_ge_u32 s5, 28
  s_cselect_b32 s74, 2, s74
  s_waitcnt vmcnt(0)
  v_mov_b32 v10, 153612
  v_mov_b32 v11, 1
  ds_write_b32 v10, v11
L_T_tag:
  s_waitcnt lgkmcnt(0)
  s_mul_i32 s6, s6, 1664525
  s_add_u32 s6, s6, 1013904223
  s_cmp_eq_u32 s79, 3
  s_cbranch_scc1 L_T3
  s_setprio 1
  s_mov_b32 s16, s48
  s_and_b32 s17, s49, 0xffff
  s_mov_b32 s18, 67108864
  s_mov_b32 s19, 0x20000
  v_lshrrev_b32 v4, 3, v1
  v_and_b32 v5, 7, v1
  v_bfe_u32 v6, v4, 1, 1
  v_lshlrev_b32 v6, 1, v6
  v_xor_b32 v6, v5, v6
  v_lshlrev_b32 v6, 4, v6
  v_lshl_add_u32 v20, v4, 9, v6
  s_sub_u32 s71, s79, 1
  s_lshl_b32 s91, s71, 2
  s_lshl_b32 s68, s71, 8
  v_add_u32 v20, s68, v20
  v_xor_b32 v21, 64, v20
  v_add_u32 v22, 128, v20
  v_add_u32 v23, 128, v21
  s_lshl_b32 s68, s4, 23
  s_lshl_b32 s69, s5, 16
  s_add_u32 s99, s68, s69
  s_add_u32 s99, s99, 6291456
  s_lshl_b32 s98, s71, 15
  s_add_u32 s98, s98, 65536
  s_mov_b32 s28, s52
  s_and_b32 s29, s53, 0xffff
  s_mov_b32 s30, 3670016
  s_mov_b32 s31, 0x20000
  v_bfe_u32 v6, v4, 1, 1
  v_lshlrev_b32 v6, 1, v6
  v_xor_b32 v5, v5, v6
  v_xor_b32 v6, 4, v5
  v_mul_u32_u24 v4, 896, v4
  v_lshl_add_u32 v24, v5, 4, v4
  v_lshl_add_u32 v25, v6, 4, v4
  s_lshl_b32 s68, s75, 8
  s_lshl_b32 s69, s71, 7
  s_add_u32 s68, s68, s69
  s_mul_i32 s97, s68, 896
  s_lshl_b32 s69, s76, 7
  s_add_u32 s97, s97, s69
  s_lshl_b32 s96, s71, 15
  v_lshlrev_b32 v32, 6, v2
  v_lshl_add_u32 v32, v3, 4, v32
  s_lshl_b32 s68, s75, 14
  s_lshl_b32 s69, s79, 12
  s_add_u32 s68, s68, s69
  s_add_u32 s68, s68, 262144
  v_add_u32 v32, s68, v32
  v_and_b32 v33, 31, v1
  v_lshlrev_b32 v33, 4, v33
  s_lshl_b32 s68, s75, 9
  s_add_u32 s68, s68, 524288
  v_add_u32 v33, s68, v33
  s_lshl_b32 s68, s79, 14
  v_bfe_u32 v4, v12, 1, 1
  v_and_b32 v5, 1, v3
  v_lshl_or_b32 v4, v5, 1, v4
  v_lshlrev_b32 v4, 5, v4
  v_lshl_add_u32 v4, v13, 3, v4
  v_lshl_add_u32 v5, v3, 3, v12
  v_lshl_add_u32 v4, v5, 7, v4
  v_add_u32 v36, s68, v4
  v_xor_b32 v37, 32, v36
  v_xor_b32 v38, 64, v36
  v_xor_b32 v39, 96, v36
  v_lshlrev_b32 v40, 4, v3
  s_lshl_b32 s68, s79, 8
  s_add_u32 s68, s68, 152064
  v_lshlrev_b32 v4, 2, v1
  v_add_u32 v41, s68, v4
  v_lshlrev_b32 v42, 3, v1
  v_add_u32 v42, 152064, v42
  v_mov_b32 v43, 2147483632
  v_mov_b32 v10, 153616
  s_mov_b32 s72, 200000
L_fw13_r:
  ds_read_b128 v[16:19], v10
  s_waitcnt lgkmcnt(0)
  v_and_b32 v16, v16, v17
  v_and_b32 v18, v18, v19
  v_and_b32 v16, v16, v18
  s_nop 0
  v_readfirstlane_b32 s73, v16
  s_nop 0
  s_cmp_eq_u32 s73, 1
  s_cbranch_scc1 L_fw13_d
  s_sub_u32 s72, s72, 1
  s_cbranch_scc0 L_fw13_r
L_fw13_d:
  s_add_u32 s68, s98, 0
  s_mov_b32 m0, s68
  s_add_u32 s69, s99, 0
  buffer_load_dwordx4 v20, s[16:19], s69 offen nt lds
  s_add_u32 s68, s98, 1024
  s_mov_b32 m0, s68
  s_add_u32 s69, s99, 4096
  buffer_load_dwordx4 v21, s[16:19], s69 offen nt lds
  s_add_u32 s68, s98, 2048
  s_mov_b32 m0, s68
  s_add_u32 s69, s99, 8192
  buffer_load_dwordx4 v20, s[16:19], s69 offen nt lds
  s_add_u32 s68, s98, 3072
  s_mov_b32 m0, s68
  s_add_u32 s69, s99, 12288
  buffer_load_dwordx4 v21, s[16:19], s69 offen nt lds
  s_add_u32 s68, s98, 16384
  s_mov_b32 m0, s68
  s_add_u32 s69, s99, 0
  buffer_load_dwordx4 v22, s[16:19], s69 offen nt lds
  s_add_u32 s68, s98, 17408
  s_mov_b32 m0, s68
  s_add_u32 s69, s99, 4096
  buffer_load_dwordx4 v23, s[16:19], s69 offen nt lds
  s_add_u32 s68, s98, 18432
  s_mov_b32 m0, s68
  s_add_u32 s69, s99, 8192
  buffer_load_dwordx4 v22, s[16:19], s69 offen nt lds
  s_add_u32 s68, s98, 19456
  s_mov_b32 m0, s68
  s_add_u32 s69, s99, 12288
  buffer_load_dwordx4 v23, s[16:19], s69 offen nt lds
  v_mov_b32 v10, 153608
  s_mov_b32 s72, 200000
L_fw14_r:
  ds_read_b32 v16, v10
  s_waitcnt lgkmcnt(0)
  v_readfirstlane_b32 s73, v16
  s_nop 0
  s_cmp_eq_u32 s73, 1
  s_cbranch_scc1 L_fw14_d
  s_sub_u32 s72, s72, 1
  s_cbranch_scc0 L_fw14_r
L_fw14_d:
  s_add_u32 s68, s98, 4096
  s_mov_b32 m0, s68
  s_add_u32 s69, s99, 16384
  buffer_load_dwordx4 v20, s[16:19], s69 offen nt lds
  s_add_u32 s68, s98, 5120
  s_mov_b32 m0, s68
  s_add_u32 s69, s99, 20480
  buffer_load_dwordx4 v21, s[16:19], s69 offen nt lds
  s_add_u32 s68, s98, 6144
  s_mov_b32 m0, s68
  s_add_u32 s69, s99, 24576
  buffer_load_dwordx4 v20, s[16:19], s69 offen nt lds
  s_add_u32 s68, s98, 7168
  s_mov_b32 m0, s68
  s_add_u32 s69, s99, 28672
  buffer_load_dwordx4 v21, s[16:19], s69 offen nt lds
  s_add_u32 s68, s98, 20480
  s_mov_b32 m0, s68
  s_add_u32 s69, s99, 16384
  buffer_load_dwordx4 v22, s[16:19], s69 offen nt lds
  s_add_u32 s68, s98, 21504
  s_mov_b32 m0, s68
  s_add_u32 s69, s99, 20480
  buffer_load_dwordx4 v23, s[16:19], s69 offen nt lds
  s_add_u32 s68, s98, 22528
  s_mov_b32 m0, s68
  s_add_u32 s69, s99, 24576
  buffer_load_dwordx4 v22, s[16:19], s69 offen nt lds
  s_add_u32 s68, s98, 23552
  s_mov_b32 m0, s68
  s_add_u32 s69, s99, 28672
  buffer_load_dwordx4 v23, s[16:19], s69 offen nt lds
  s_add_u32 s68, s98, 8192
  s_mov_b32 m0, s68
  s_add_u32 s69, s99, 32768
  buffer_load_dwordx4 v20, s[16:19], s69 offen nt lds
  s_add_u32 s68, s98, 9216
  s_mov_b32 m0, s68
  s_add_u32 s69, s99, 36864
  buffer_load_dwordx4 v21, s[16:19], s69 offen nt lds
  s_add_u32 s68, s98, 10240
  s_mov_b32 m0, s68
  s_add_u32 s69, s99, 40960
  buffer_load_dwordx4 v20, s[16:19], s69 offen nt lds
  s_add_u32 s68, s98, 11264
  s_mov_b32 m0, s68
  s_add_u32 s69, s99, 45056
  buffer_load_dwordx4 v21, s[16:19], s69 offen nt lds
  s_add_u32 s68, s98, 24576
  s_mov_b32 m0, s68
  s_add_u32 s69, s99, 32768
  buffer_load_dwordx4 v22, s[16:19], s69 offen nt lds
  s_add_u32 s68, s98, 25600
  s_mov_b32 m0, s68
  s_add_u32 s69, s99, 36864
  buffer_load_dwordx4 v23, s[16:19], s69 offen nt lds
  s_add_u32 s68, s98, 26624
  s_mov_b32 m0, s68
  s_add_u32 s69, s99, 40960
  buffer_load_dwordx4 v22, s[16:19], s69 offen nt lds
  s_add_u32 s68, s98, 27648
  s_mov_b32 m0, s68
  s_add_u32 s69, s99, 45056
  buffer_load_dwordx4 v23, s[16:19], s69 offen nt lds
  s_waitcnt vmcnt(16)
  s_lshl_b32 s73, s91, 2
  s_add_u32 s73, s73, 153680
  v_mov_b32 v10, s73
  v_mov_b32 v11, 1
  ds_write_b32 v10, v11
  s_add_u32 s68, s98, 12288
  s_mov_b32 m0, s68
  s_add_u32 s69, s99, 49152
  buffer_load_dwordx4 v20, s[16:19], s69 offen nt lds
  s_add_u32 s68, s98, 13312
  s_mov_b32 m0, s68
  s_add_u32 s69, s99, 53248
  buffer_load_dwordx4 v21, s[16:19], s69 offen nt lds
  s_add_u32 s68, s98, 14336
  s_mov_b32 m0, s68
  s_add_u32 s69, s99, 57344
  buffer_load_dwordx4 v20, s[16:19], s69 offen nt lds
  s_add_u32 s68, s98, 15360
  s_mov_b32 m0, s68
  s_add_u32 s69, s99, 61440
  buffer_load_dwordx4 v21, s[16:19], s69 offen nt lds
  s_add_u32 s68, s98, 28672
  s_mov_b32 m0, s68
  s_add_u32 s69, s99, 49152
  buffer_load_dwordx4 v22, s[16:19], s69 offen nt lds
  s_add_u32 s68, s98, 29696
  s_mov_b32 m0, s68
  s_add_u32 s69, s99, 53248
  buffer_load_dwordx4 v23, s[16:19], s69 offen nt lds
  s_add_u32 s68, s98, 30720
  s_mov_b32 m0, s68
  s_add_u32 s69, s99, 57344
  buffer_load_dwordx4 v22, s[16:19], s69 offen nt lds
  s_add_u32 s68, s98, 31744
  s_mov_b32 m0, s68
  s_add_u32 s69, s99, 61440
  buffer_load_dwordx4 v23, s[16:19], s69 offen nt lds
  s_waitcnt vmcnt(16)
  s_lshl_b32 s73, s91, 2
  s_add_u32 s73, s73, 153684
  v_mov_b32 v10, s73
  v_mov_b32 v11, 1
  ds_write_b32 v10, v11
  s_waitcnt vmcnt(8)
  s_lshl_b32 s73, s91, 2
  s_add_u32 s73, s73, 153688
  v_mov_b32 v10, s73
  v_mov_b32 v11, 1
  ds_write_b32 v10, v11
  s_cmp_lg_u32 s74, 0
  s_cbranch_scc1 L_vl_now
  v_mov_b32 v10, 153632
  s_mov_b32 s72, 200000
L_fw15_r:
  ds_read_b128 v[16:19], v10
  s_waitcnt lgkmcnt(0)
  v_and_b32 v16, v16, v17
  v_and_b32 v18, v18, v19
  v_and_b32 v16, v16, v18
  s_nop 0
  v_readfirstlane_b32 s73, v16
  s_nop 0
  s_cmp_eq_u32 s73, 1
  s_cbranch_scc1 L_fw15_d
  s_sub_u32 s72, s72, 1
  s_cbranch_scc0 L_fw15_r
L_fw15_d:
  s_mov_b32 m0, s96
  s_add_u32 s96, s96, 1024
  buffer_load_dwordx4 v24, s[28:31], s97 offen nt lds
  s_add_u32 s97, s97, 7168
  s_mov_b32 m0, s96
  s_add_u32 s96, s96, 1024
  buffer_load_dwordx4 v25, s[28:31], s97 offen nt lds
  s_add_u32 s97, s97, 7168
  s_mov_b32 m0, s96
  s_add_u32 s96, s96, 1024
  buffer_load_dwordx4 v24, s[28:31], s97 offen nt lds
  s_add_u32 s97, s97, 7168
  s_mov_b32 m0, s96
  s_add_u32 s96, s96, 1024
  buffer_load_dwordx4 v25, s[28:31], s97 offen nt lds
  s_add_u32 s97, s97, 7168
  s_mov_b32 m0, s96
  s_add_u32 s96, s96, 1024
  buffer_load_dwordx4 v24, s[28:31], s97 offen nt lds
  s_add_u32 s97, s97, 7168
  s_mov_b32 m0, s96
  s_add_u32 s96, s96, 1024
  buffer_load_dwordx4 v25, s[28:31], s97 offen nt lds
  s_add_u32 s97, s97, 7168
  s_mov_b32 m0, s96
  s_add_u32 s96, s96, 1024
  buffer_load_dwordx4 v24, s[28:31], s97 offen nt lds
  s_add_u32 s97, s97, 7168
  s_mov_b32 m0, s96
  s_add_u32 s96, s96, 1024
  buffer_load_dwordx4 v25, s[28:31], s97 offen nt lds
  s_add_u32 s97, s97, 7168
  s_add_u32 s96, s96, 8192
  s_mov_b32 m0, s96
  s_add_u32 s96, s96, 1024
  buffer_load_dwordx4 v24, s[28:31], s97 offen nt lds
  s_add_u32 s97, s97, 7168
  s_mov_b32 m0, s96
  s_add_u32 s96, s96, 1024
  buffer_load_dwordx4 v25, s[28:31], s97 offen nt lds
  s_add_u32 s97, s97, 7168
  s_mov_b32 m0, s96
  s_add_u32 s96, s96, 1024
  buffer_load_dwordx4 v24, s[28:31], s97 offen nt lds
  s_add_u32 s97, s97, 7168
  s_mov_b32 m0, s96
  s_add_u32 s96, s96, 1024
  buffer_load_dwordx4 v25, s[28:31], s97 offen nt lds
  s_add_u32 s97, s97, 7168
  s_mov_b32 m0, s96
  s_add_u32 s96, s96, 1024
  buffer_load_dwordx4 v24, s[28:31], s97 offen nt lds
  s_add_u32 s97, s97, 7168
  s_mov_b32 m0, s96
  s_add_u32 s96, s96, 1024
  buffer_load_dwordx4 v25, s[28:31], s97 offen nt lds
  s_add_u32 s97, s97, 7168
  s_mov_b32 m0, s96
  s_add_u32 s96, s96, 1024
  buffer_load_dwordx4 v24, s[28:31], s97 offen nt lds
  s_add_u32 s97, s97, 7168
  s_mov_b32 m0, s96
  s_add_u32 s96, s96, 1024
  buffer_load_dwordx4 v25, s[28:31], s97 offen nt lds
  s_add_u32 s97, s97, 7168
  s_add_u32 s96, s96, 8192
  s_waitcnt vmcnt(16)
  s_lshl_b32 s73, s91, 2
  s_add_u32 s73, s73, 153692
  v_mov_b32 v10, s73
  v_mov_b32 v11, 1
  ds_write_b32 v10, v11
  s_waitcnt vmcnt(0)
  s_lshl_b32 s73, s71, 2
  s_add_u32 s73, s73, 153720
  v_mov_b32 v10, s73
  v_mov_b32 v11, 1
  ds_write_b32 v10, v11
  s_setprio 0
  s_branch L_T_roles
L_vl_now:
  s_waitcnt vmcnt(0)
  s_lshl_b32 s73, s91, 2
  s_add_u32 s73, s73, 153692
  v_mov_b32 v10, s73
  v_mov_b32 v11, 1
  ds_write_b32 v10, v11
  s_setprio 0
  s_branch L_T_roles
L_T3:
  v_lshlrev_b32 v32, 6, v2
  v_lshl_add_u32 v32, v3, 4, v32
  s_lshl_b32 s68, s75, 14
  s_lshl_b32 s69, s79, 12
  s_add_u32 s68, s68, s69
  s_add_u32 s68, s68, 262144
  v_add_u32 v32, s68, v32
  v_and_b32 v33, 31, v1
  v_lshlrev_b32 v33, 4, v33
  s_lshl_b32 s68, s75, 9
  s_add_u32 s68, s68, 524288
  v_add_u32 v33, s68, v33
  s_lshl_b32 s68, s79, 14
  v_bfe_u32 v4, v12, 1, 1
  v_and_b32 v5, 1, v3
  v_lshl_or_b32 v4, v5, 1, v4
  v_lshlrev_b32 v4, 5, v4
  v_lshl_add_u32 v4, v13, 3, v4
  v_lshl_add_u32 v5, v3, 3, v12
  v_lshl_add_u32 v4, v5, 7, v4
  v_add_u32 v36, s68, v4
  v_xor_b32 v37, 32, v36
  v_xor_b32 v38, 64, v36
  v_xor_b32 v39, 96, v36
  v_lshlrev_b32 v40, 4, v3
  s_lshl_b32 s68, s79, 8
  s_add_u32 s68, s68, 152064
  v_lshlrev_b32 v4, 2, v1
  v_add_u32 v41, s68, v4
  v_lshlrev_b32 v42, 3, v1
  v_add_u32 v42, 152064, v42
  v_mov_b32 v43, 2147483632
  v_mov_b32 v10, 153632
  s_mov_b32 s72, 200000
L_fw16_r:
  ds_read_b128 v[16:19], v10
  s_waitcnt lgkmcnt(0)
  v_and_b32 v16, v16, v17
  v_and_b32 v18, v18, v19
  v_and_b32 v16, v16, v18
  s_nop 0
  v_readfirstlane_b32 s73, v16
  s_nop 0
  s_cmp_eq_u32 s73, 1
  s_cbranch_scc1 L_fw16_d
  s_sub_u32 s72, s72, 1
  s_cbranch_scc0 L_fw16_r
L_fw16_d:
  v_lshlrev_b32 v4, 4, v1
  v_add_u32 v4, 4096, v4
L_tok_retry:
  buffer_load_dwordx4 v[8:11], v4, s[8:11], 0 offen sc1
  s_waitcnt vmcnt(0)
  v_xor_b32 v5, s6, v8
  v_xor_b32 v6, s6, v9
  v_or_b32 v5, v5, v6
  v_xor_b32 v6, s6, v10
  v_or_b32 v5, v5, v6
  v_xor_b32 v6, s6, v11
  v_or_b32 v5, v5, v6
  v_cmp_ne_u32 vcc, 0, v5
  s_nop 0
  s_and_b64 vcc, exec, vcc
  s_cbranch_vccz L_tok_ok
  s_sub_u32 s7, s7, 1
  s_cbranch_scc0 L_tok_retry
L_tok_ok:
  v_mov_b32 v10, 153776
  v_mov_b32 v11, 1
  ds_write_b32 v10, v11
L_T_roles:
  s_cmp_eq_u32 s74, 1
  s_cbranch_scc1 L_role_f
  s_cmp_eq_u32 s74, 2
  s_cbranch_scc1 L_role_o
  s_mov_b32 s24, s44
  s_and_b32 s25, s45, 0xffff
  s_mov_b32 s26, 896
  s_mov_b32 s27, 0x20000
  s_cmp_lg_u32 s79, 0
  s_cbranch_scc1 L_w_go
  v_lshlrev_b32 v32, 6, v2
  v_lshl_add_u32 v32, v3, 4, v32
  s_lshl_b32 s68, s75, 14
  s_lshl_b32 s69, s79, 12
  s_add_u32 s68, s68, s69
  s_add_u32 s68, s68, 262144
  v_add_u32 v32, s68, v32
  v_and_b32 v33, 31, v1
  v_lshlrev_b32 v33, 4, v33
  s_lshl_b32 s68, s75, 9
  s_add_u32 s68, s68, 524288
  v_add_u32 v33, s68, v33
  s_lshl_b32 s68, s79, 14
  v_bfe_u32 v4, v12, 1, 1
  v_and_b32 v5, 1, v3
  v_lshl_or_b32 v4, v5, 1, v4
  v_lshlrev_b32 v4, 5, v4
  v_lshl_add_u32 v4, v13, 3, v4
  v_lshl_add_u32 v5, v3, 3, v12
  v_lshl_add_u32 v4, v5, 7, v4
  v_add_u32 v36, s68, v4
  v_xor_b32 v37, 32, v36
  v_xor_b32 v38, 64, v36
  v_xor_b32 v39, 96, v36
  v_lshlrev_b32 v40, 4, v3
  s_lshl_b32 s68, s79, 8
  s_add_u32 s68, s68, 152064
  v_lshlrev_b32 v4, 2, v1
  v_add_u32 v41, s68, v4
  v_lshlrev_b32 v42, 3, v1
  v_add_u32 v42, 152064, v42
  v_lshlrev_b32 v4, 2, v1
  s_lshl_b32 s68, s76, 7
  v_add_u32 v4, s68, v4
  s_cmp_eq_u32 s75, 0
  s_cselect_b32 s69, 128, 0
  s_add_u32 s69, s69, s68
  v_mov_b32 v9, 2147483632
  v_cmp_gt_u32 vcc, s69, v4
  s_nop 1
  v_cndmask_b32 v5, v9, v4, vcc
  buffer_load_dword v44, v5, s[24:27], 0 offen
  v_lshlrev_b32 v4, 10, v3
  v_lshl_add_u32 v4, v2, 2, v4
  s_lshl_b32 s68, s76, 11
  s_lshl_b32 s69, s75, 6
  s_add_u32 s68, s68, s69
  s_add_u32 s68, s68, 540672
  v_add_u32 v4, s68, v4
  v_mov_b32 v9, 2147483632
  v_cmp_gt_u32 vcc, 32, v1
  s_nop 1
  v_cndmask_b32 v43, v9, v4, vcc
L_w_go:
  v_mov_b32 v10, 153776
  s_mov_b32 s72, 200000
L_fw17_r:
  ds_read_b32 v16, v10
  s_waitcnt lgkmcnt(0)
  v_readfirstlane_b32 s73, v16
  s_nop 0
  s_cmp_eq_u32 s73, 1
  s_cbranch_scc1 L_fw17_d
  s_sub_u32 s72, s72, 1
  s_cbranch_scc0 L_fw17_r
L_fw17_d:
  v_mov_b32 v10, 153744
  s_mov_b32 s72, 200000
L_fw18_r:
  ds_read_b128 v[16:19], v10
  s_waitcnt lgkmcnt(0)
  v_and_b32 v16, v16, v17
  v_and_b32 v18, v18, v19
  v_and_b32 v16, v16, v18
  s_nop 0
  v_readfirstlane_b32 s73, v16
  s_nop 0
  s_cmp_eq_u32 s73, 1
  s_cbranch_scc1 L_fw18_d
  s_sub_u32 s72, s72, 1
  s_cbranch_scc0 L_fw18_r
L_fw18_d:
  buffer_load_dwordx4 v[96:99], v32, s[8:11], 0 offen offset:0 sc1
  buffer_load_dwordx4 v[100:103], v32, s[8:11], 0 offen offset:2048 sc1
  buffer_load_dwordx4 v[104:107], v32, s[8:11], 0 offen offset:1024 sc1
  buffer_load_dwordx4 v[108:111], v32, s[8:11], 0 offen offset:3072 sc1
  buffer_load_dwordx2 v[46:47], v33, s[8:11], 0 offen sc1
  v_mov_b32 v10, 153720
  s_mov_b32 s72, 200000
L_fw19_r:
  ds_read_b64 v[16:17], v10
  s_waitcnt lgkmcnt(0)
  v_and_b32 v16, v16, v17
  s_nop 0
  v_readfirstlane_b32 s73, v16
  s_nop 0
  s_cmp_eq_u32 s73, 1
  s_cbranch_scc1 L_fw19_d
  s_sub_u32 s72, s72, 1
  s_cbranch_scc0 L_fw19_r
L_fw19_d:
  ds_read_b64_tr_b16 v[64:65], v36 offset:0
  ds_read_b64_tr_b16 v[66:67], v36 offset:512
  ds_read_b64_tr_b16 v[68:69], v37 offset:0
  ds_read_b64_tr_b16 v[70:71], v37 offset:512
  ds_read_b64_tr_b16 v[72:73], v38 offset:0
  ds_read_b64_tr_b16 v[74:75], v38 offset:512
  ds_read_b64_tr_b16 v[76:77], v39 offset:0
  ds_read_b64_tr_b16 v[78:79], v39 offset:512
  ds_read_b64_tr_b16 v[80:81], v36 offset:4096
  ds_read_b64_tr_b16 v[82:83], v36 offset:4608
  ds_read_b64_tr_b16 v[84:85], v37 offset:4096
  ds_read_b64_tr_b16 v[86:87], v37 offset:4608
  ds_read_b64_tr_b16 v[88:89], v38 offset:4096
  ds_read_b64_tr_b16 v[90:91], v38 offset:4608
  ds_read_b64_tr_b16 v[92:93], v39 offset:4096
  ds_read_b64_tr_b16 v[94:95], v39 offset:4608
  s_branch L_w_w
L_w_r:
  buffer_load_dwordx4 v[96:99], v32, s[8:11], 0 offen offset:0 sc1
  buffer_load_dwordx4 v[100:103], v32, s[8:11], 0 offen offset:2048 sc1
  buffer_load_dwordx4 v[104:107], v32, s[8:11], 0 offen offset:1024 sc1
  buffer_load_dwordx4 v[108:111], v32, s[8:11], 0 offen offset:3072 sc1
  buffer_load_dwordx2 v[46:47], v33, s[8:11], 0 offen sc1
L_w_w:
  s_waitcnt vmcnt(0)
  v_max3_u32 v4, v96, v97, v98
  v_max3_u32 v5, v99, v100, v101
  v_max3_u32 v6, v102, v103, v104
  v_max3_u32 v7, v105, v106, v107
  v_max3_u32 v4, v4, v108, v109
  v_max3_u32 v5, v5, v110, v111
  v_max3_u32 v6, v6, v46, v47
  v_max3_u32 v4, v4, v5, v6
  v_max_u32 v4, v4, v7
  v_cmp_eq_u32 vcc, -1, v4
  s_nop 0
  s_and_b64 vcc, exec, vcc
  s_cbranch_vccz L_w_ok
  s_sub_u32 s7, s7, 1
  s_cbranch_scc0 L_w_r
L_w_ok:
  v_mov_b32 v48, v46
  s_waitcnt lgkmcnt(0)
  v_mfma_f32_16x16x32_bf16 v[116:119], v[96:99], v[64:67], 0
  v_max_f32_dpp v48, v48, v48 row_ror:8 row_mask:0xf bank_mask:0xf
  v_mfma_f32_16x16x32_bf16 v[120:123], v[96:99], v[68:71], 0
  v_mfma_f32_16x16x32_bf16 v[124:127], v[96:99], v[72:75], 0
  v_max_f32_dpp v48, v48, v48 row_ror:4 row_mask:0xf bank_mask:0xf
  v_mfma_f32_16x16x32_bf16 v[128:131], v[96:99], v[76:79], 0
  v_mfma_f32_16x16x32_bf16 v[116:119], v[100:103], v[80:83], v[116:119]
  v_max_f32_dpp v48, v48, v48 row_ror:2 row_mask:0xf bank_mask:0xf
  v_mfma_f32_16x16x32_bf16 v[120:123], v[100:103], v[84:87], v[120:123]
  v_mfma_f32_16x16x32_bf16 v[124:127], v[100:103], v[88:91], v[124:127]
  v_max_f32_dpp v48, v48, v48 row_ror:1 row_mask:0xf bank_mask:0xf
  v_mfma_f32_16x16x32_bf16 v[128:131], v[100:103], v[92:95], v[128:131]
  v_mov_b32 v4, v48
  v_mfma_f32_16x16x32_bf16 v[132:135], v[104:107], v[64:67], 0
  v_mfma_f32_16x16x32_bf16 v[136:139], v[104:107], v[68:71], 0
  v_permlane16_swap_b32 v48, v4
  v_max_f32 v48, v48, v4
  v_sub_f32 v49, v46, v48
  v_exp_f32 v49, v49
  v_mfma_f32_16x16x32_bf16 v[140:143], v[104:107], v[72:75], 0
  ds_bpermute_b32 v52, v40, v49 offset:0
  ds_bpermute_b32 v53, v40, v49 offset:4
  v_mfma_f32_16x16x32_bf16 v[144:147], v[104:107], v[76:79], 0
  ds_bpermute_b32 v54, v40, v49 offset:8
  ds_bpermute_b32 v55, v40, v49 offset:12
  v_mfma_f32_16x16x32_bf16 v[132:135], v[108:111], v[80:83], v[132:135]
  ds_bpermute_b32 v56, v40, v49 offset:64
  ds_bpermute_b32 v57, v40, v49 offset:68
  v_mfma_f32_16x16x32_bf16 v[136:139], v[108:111], v[84:87], v[136:139]
  ds_bpermute_b32 v58, v40, v49 offset:72
  ds_bpermute_b32 v59, v40, v49 offset:76
  v_mfma_f32_16x16x32_bf16 v[140:143], v[108:111], v[88:91], v[140:143]
  v_mul_f32 v50, v49, v47
  v_mfma_f32_16x16x32_bf16 v[144:147], v[108:111], v[92:95], v[144:147]
  s_waitcnt lgkmcnt(4)
  v_mul_f32 v160, v52, v116
  v_mul_f32 v161, v52, v120
  v_mul_f32 v162, v52, v124
  v_mul_f32 v163, v52, v128
  v_add_f32_dpp v50, v50, v50 row_ror:8 row_mask:0xf bank_mask:0xf
  v_fmac_f32 v160, v53, v117
  v_fmac_f32 v161, v53, v121
  v_fmac_f32 v162, v53, v125
  v_fmac_f32 v163, v53, v129
  v_add_f32_dpp v50, v50, v50 row_ror:4 row_mask:0xf bank_mask:0xf
  v_fmac_f32 v160, v54, v118
  v_fmac_f32 v161, v54, v122
  v_fmac_f32 v162, v54, v126
  v_fmac_f32 v163, v54, v130
  v_add_f32_dpp v50, v50, v50 row_ror:2 row_mask:0xf bank_mask:0xf
  v_fmac_f32 v160, v55, v119
  v_fmac_f32 v161, v55, v123
  v_fmac_f32 v162, v55, v127
  v_fmac_f32 v163, v55, v131
  v_add_f32_dpp v50, v50, v50 row_ror:1 row_mask:0xf bank_mask:0xf
  s_waitcnt lgkmcnt(0)
  v_fmac_f32 v160, v56, v132
  v_fmac_f32 v161, v56, v136
  v_fmac_f32 v162, v56, v140
  v_fmac_f32 v163, v56, v144
  v_mov_b32 v4, v50
  v_fmac_f32 v160, v57, v133
  v_fmac_f32 v161, v57, v137
  v_fmac_f32 v162, v57, v141
  v_fmac_f32 v163, v57, v145
  v_permlane16_swap_b32 v50, v4
  v_fmac_f32 v160, v58, v134
  v_fmac_f32 v161, v58, v138
  v_fmac_f32 v162, v58, v142
  v_fmac_f32 v163, v58, v146
  v_add_f32 v50, v50, v4
  v_fmac_f32 v160, v59, v135
  v_fmac_f32 v161, v59, v139
  v_fmac_f32 v162, v59, v143
  v_fmac_f32 v163, v59, v147
  v_rcp_f32 v50, v50
  v_permlane16_swap_b32 v160, v161
  v_permlane16_swap_b32 v162, v163
  v_add_f32 v160, v160, v161
  v_add_f32 v162, v162, v163
  s_nop 1
  v_permlane32_swap_b32 v160, v162
  v_add_f32 v160, v160, v162
  ds_write_b32 v41, v160
  s_waitcnt lgkmcnt(0)
  s_barrier
  s_cmp_lg_u32 s79, 0
  s_cbranch_scc1 L_end
  ds_read_b64 v[160:161], v42 offset:0
  ds_read_b64 v[162:163], v42 offset:256
  ds_read_b64 v[164:165], v42 offset:512
  ds_read_b64 v[166:167], v42 offset:768
  v_lshlrev_b32 v45, 16, v44
  v_and_b32 v44, 0xffff0000, v44
  s_waitcnt lgkmcnt(2)
  v_add_f32 v160, v160, v162
  v_add_f32 v161, v161, v163
  s_waitcnt lgkmcnt(0)
  v_add_f32 v164, v164, v166
  v_add_f32 v165, v165, v167
  v_add_f32 v160, v160, v164
  v_add_f32 v161, v161, v165
  v_fma_f32 v160, v160, v50, v45
  v_fma_f32 v161, v161, v50, v44
  v_cvt_pk_bf16_f32 v160, v160, v161
  v_min_u32 v160, -2, v160
  buffer_store_dword v160, v43, s[8:11], 0 offen sc1
  s_endpgm
L_role_f:
  v_mov_b32 v10, 153728
  s_mov_b32 s72, 200000
L_fw20_r:
  ds_read_b128 v[16:19], v10
  s_waitcnt lgkmcnt(0)
  v_and_b32 v16, v16, v17
  v_and_b32 v18, v18, v19
  v_and_b32 v16, v16, v18
  s_nop 0
  v_readfirstlane_b32 s73, v16
  s_nop 0
  s_cmp_eq_u32 s73, 1
  s_cbranch_scc1 L_fw20_d
  s_sub_u32 s72, s72, 1
  s_cbranch_scc0 L_fw20_r
L_fw20_d:
  s_mov_b32 s28, s56
  s_and_b32 s29, s57, 0xffff
  s_mov_b32 s30, 1605632
  s_mov_b32 s31, 0x20000
  s_mov_b32 s32, s58
  s_and_b32 s33, s59, 0xffff
  s_mov_b32 s34, 1605632
  s_mov_b32 s35, 0x20000
  s_mov_b32 s36, s60
  s_and_b32 s37, s61, 0xffff
  s_mov_b32 s38, 1605632
  s_mov_b32 s39, 0x20000
  s_lshl_b32 s68, s77, 4
  s_mul_i32 s68, s68, 896
  s_lshl_b32 s69, s79, 10
  s_add_u32 s69, s69, 131072
  s_lshl_b32 s71, s79, 6
  v_add_u32 v4, s71, v1
  v_mul_u32_u24 v5, 1171, v4
  v_lshrrev_b32 v5, 16, v5
  v_mul_u32_u24 v6, 56, v5
  v_sub_u32 v4, v4, v6
  v_bfe_u32 v6, v5, 1, 2
  v_lshlrev_b32 v6, 1, v6
  v_xor_b32 v4, v4, v6
  v_mul_u32_u24 v5, 896, v5
  v_lshl_add_u32 v20, v4, 4, v5
  s_mov_b32 m0, s69
  s_add_u32 s69, s69, 4096
  buffer_load_dwordx4 v20, s[36:39], s68 offen nt lds
  s_add_u32 s71, s71, 256
  v_add_u32 v4, s71, v1
  v_mul_u32_u24 v5, 1171, v4
  v_lshrrev_b32 v5, 16, v5
  v_mul_u32_u24 v6, 56, v5
  v_sub_u32 v4, v4, v6
  v_bfe_u32 v6, v5, 1, 2
  v_lshlrev_b32 v6, 1, v6
  v_xor_b32 v4, v4, v6
  v_mul_u32_u24 v5, 896, v5
  v_lshl_add_u32 v21, v4, 4, v5
  s_mov_b32 m0, s69
  s_add_u32 s69, s69, 4096
  buffer_load_dwordx4 v21, s[36:39], s68 offen nt lds
  s_add_u32 s71, s71, 256
  v_add_u32 v4, s71, v1
  v_mul_u32_u24 v5, 1171, v4
  v_lshrrev_b32 v5, 16, v5
  v_mul_u32_u24 v6, 56, v5
  v_sub_u32 v4, v4, v6
  v_bfe_u32 v6, v5, 1, 2
  v_lshlrev_b32 v6, 1, v6
  v_xor_b32 v4, v4, v6
  v_mul_u32_u24 v5, 896, v5
  v_lshl_add_u32 v22, v4, 4, v5
  s_mov_b32 m0, s69
  s_add_u32 s69, s69, 4096
  buffer_load_dwordx4 v22, s[36:39], s68 offen nt lds
  s_add_u32 s71, s71, 256
  s_cmp_ge_u32 s79, 2
  s_cselect_b32 s70, 256, 0
  s_sub_u32 s71, s71, s70
  s_cmp_ge_u32 s79, 2
  s_cselect_b32 s70, 4096, 0
  s_sub_u32 s69, s69, s70
  v_add_u32 v4, s71, v1
  v_mul_u32_u24 v5, 1171, v4
  v_lshrrev_b32 v5, 16, v5
  v_mul_u32_u24 v6, 56, v5
  v_sub_u32 v4, v4, v6
  v_bfe_u32 v6, v5, 1, 2
  v_lshlrev_b32 v6, 1, v6
  v_xor_b32 v4, v4, v6
  v_mul_u32_u24 v5, 896, v5
  v_lshl_add_u32 v23, v4, 4, v5
  s_mov_b32 m0, s69
  s_add_u32 s69, s69, 4096
  buffer_load_dwordx4 v23, s[36:39], s68 offen nt lds
  s_add_u32 s71, s71, 256
  v_lshrrev_b32 v4, 1, v1
  v_bfe_u32 v5, v4, 3, 1
  v_lshlrev_b32 v5, 2, v5
  v_xor_b32 v4, v4, v5
  v_mul_u32_u24 v4, 3584, v4
  v_and_b32 v5, 1, v1
  v_lshl_add_u32 v4, v5, 4, v4
  s_cmp_ge_u32 s79, 2
  s_cselect_b32 s71, 2, 3
  s_add_u32 s70, s77, 0
  s_and_b32 s70, s70, 3
  s_min_u32 s70, s70, s71
  s_lshl_b32 s68, s70, 2
  s_add_u32 s68, s68, s79
  s_mul_i32 s68, s68, 114688
  s_lshl_b32 s69, s77, 5
  s_add_u32 s68, s68, s69
  s_lshl_b32 s69, s79, 14
  s_lshl_b32 s70, s70, 10
  s_add_u32 s69, s69, s70
  s_mov_b32 m0, s69
  s_add_u32 s70, s69, 4096
  buffer_load_dwordx4 v4, s[28:31], s68 offen  lds
  s_mov_b32 m0, s70
  s_nop 0
  buffer_load_dwordx4 v4, s[32:35], s68 offen  lds
  s_waitcnt vmcnt(0)
  s_add_u32 s70, s77, 1
  s_and_b32 s70, s70, 3
  s_min_u32 s70, s70, s71
  s_lshl_b32 s68, s70, 2
  s_add_u32 s68, s68, s79
  s_mul_i32 s68, s68, 114688
  s_lshl_b32 s69, s77, 5
  s_add_u32 s68, s68, s69
  s_lshl_b32 s69, s79, 14
  s_lshl_b32 s70, s70, 10
  s_add_u32 s69, s69, s70
  s_mov_b32 m0, s69
  s_add_u32 s70, s69, 4096
  buffer_load_dwordx4 v4, s[28:31], s68 offen  lds
  s_mov_b32 m0, s70
  s_nop 0
  buffer_load_dwordx4 v4, s[32:35], s68 offen  lds
  s_add_u32 s70, s77, 2
  s_and_b32 s70, s70, 3
  s_min_u32 s70, s70, s71
  s_lshl_b32 s68, s70, 2
  s_add_u32 s68, s68, s79
  s_mul_i32 s68, s68, 114688
  s_lshl_b32 s69, s77, 5
  s_add_u32 s68, s68, s69
  s_lshl_b32 s69, s79, 14
  s_lshl_b32 s70, s70, 10
  s_add_u32 s69, s69, s70
  s_mov_b32 m0, s69
  s_add_u32 s70, s69, 4096
  buffer_load_dwordx4 v4, s[28:31], s68 offen  lds
  s_mov_b32 m0, s70
  s_nop 0
  buffer_load_dwordx4 v4, s[32:35], s68 offen  lds
  s_add_u32 s70, s77, 3
  s_and_b32 s70, s70, 3
  s_min_u32 s70, s70, s71
  s_lshl_b32 s68, s70, 2
  s_add_u32 s68, s68, s79
  s_mul_i32 s68, s68, 114688
  s_lshl_b32 s69, s77, 5
  s_add_u32 s68, s68, s69
  s_lshl_b32 s69, s79, 14
  s_lshl_b32 s70, s70, 10
  s_add_u32 s69, s69, s70
  s_mov_b32 m0, s69
  s_add_u32 s70, s69, 4096
  buffer_load_dwordx4 v4, s[28:31], s68 offen  lds
  s_mov_b32 m0, s70
  s_nop 0
  buffer_load_dwordx4 v4, s[32:35], s68 offen  lds
  v_lshlrev_b32 v32, 6, v2
  v_lshl_add_u32 v32, v3, 4, v32
  s_lshl_b32 s68, s79, 10
  s_add_u32 s68, s68, 540672
  v_add_u32 v32, s68, v32
  s_mov_b32 s97, 4096
  s_mov_b32 s98, 8192
  s_cmp_ge_u32 s79, 2
  s_cselect_b32 s99, 0, 12288
  v_lshl_add_u32 v4, v3, 3, v12
  v_lshlrev_b32 v4, 5, v4
  v_lshl_add_u32 v4, v13, 3, v4
  v_and_b32 v5, 1, v3
  v_lshl_add_u32 v4, v5, 7, v4
  s_lshl_b32 s68, s79, 14
  v_add_u32 v34, s68, v4
  v_xor_b32 v35, 128, v34
  v_lshl_add_u32 v4, v3, 2, v12
  v_bfe_u32 v5, v4, 1, 2
  v_mul_u32_u24 v4, 896, v4
  v_lshl_add_u32 v4, v13, 3, v4
  v_add_u32 v4, 131072, v4
  s_mul_i32 s68, s79, 7
  s_add_u32 s69, s68, 0
  v_xor_b32 v6, s69, v5
  v_lshl_add_u32 v36, v6, 5, v4
  s_add_u32 s69, s68, 1
  v_xor_b32 v6, s69, v5
  v_lshl_add_u32 v37, v6, 5, v4
  s_add_u32 s69, s68, 2
  v_xor_b32 v6, s69, v5
  v_lshl_add_u32 v38, v6, 5, v4
  s_add_u32 s69, s68, 3
  v_xor_b32 v6, s69, v5
  v_lshl_add_u32 v39, v6, 5, v4
  s_add_u32 s69, s68, 4
  v_xor_b32 v6, s69, v5
  v_lshl_add_u32 v40, v6, 5, v4
  s_add_u32 s69, s68, 5
  v_xor_b32 v6, s69, v5
  v_lshl_add_u32 v41, v6, 5, v4
  s_add_u32 s69, s68, 6
  v_xor_b32 v6, s69, v5
  v_lshl_add_u32 v42, v6, 5, v4
  v_mov_b32 v44, 0x3f803f80
  v_mov_b32 v45, 0x3f803f80
  v_mov_b32 v46, 0x3f803f80
  v_mov_b32 v47, 0x3f803f80
  v_and_b32 v4, 3, v2
  v_lshl_add_u32 v48, v3, 2, v4
  v_lshlrev_b32 v48, 4, v48
  s_lshl_b32 s68, s79, 2
  s_add_u32 s69, s68, 152064
  v_lshlrev_b32 v49, 4, v1
  v_add_u32 v49, s69, v49
  v_add_u32 v50, 152064, v48
  v_mov_b32 v51, 152064
  v_cmp_eq_u32 s[80:81], 1, v3
  v_cmp_eq_u32 s[82:83], 2, v3
  v_cmp_eq_u32 s[84:85], 3, v3
  s_mul_i32 s70, s79, 50176
  s_lshl_b32 s69, s77, 6
  s_add_u32 s70, s70, s69
  s_add_u32 s70, s70, 557056
  v_mul_u32_u24 v52, 7168, v3
  v_lshl_add_u32 v52, v2, 2, v52
  v_add_u32 v52, s70, v52
  v_add_u32 v53, 28672, v52
  v_mov_b32 v7, 2147483632
  v_cndmask_b32 v53, v53, v7, s[84:85]
  v_mov_b32 v10, 153776
  s_mov_b32 s72, 200000
L_fw21_r:
  ds_read_b32 v16, v10
  s_waitcnt lgkmcnt(0)
  v_readfirstlane_b32 s73, v16
  s_nop 0
  s_cmp_eq_u32 s73, 1
  s_cbranch_scc1 L_fw21_d
  s_sub_u32 s72, s72, 1
  s_cbranch_scc0 L_fw21_r
L_fw21_d:
  s_waitcnt vmcnt(0)
  buffer_load_dwordx4 v[120:123], v32, s[8:11], 0 offen sc1
  buffer_load_dwordx4 v[124:127], v32, s[8:11], s97 offen sc1
  buffer_load_dwordx4 v[128:131], v32, s[8:11], s98 offen sc1
  buffer_load_dwordx4 v[132:135], v32, s[8:11], s99 offen sc1
  ds_read_b64_tr_b16 v[64:65], v34 offset:0
  ds_read_b64_tr_b16 v[66:67], v35 offset:0
  ds_read_b64_tr_b16 v[80:81], v34 offset:4096
  ds_read_b64_tr_b16 v[82:83], v35 offset:4096
  ds_read_b64_tr_b16 v[68:69], v34 offset:1024
  ds_read_b64_tr_b16 v[70:71], v35 offset:1024
  ds_read_b64_tr_b16 v[84:85], v34 offset:5120
  ds_read_b64_tr_b16 v[86:87], v35 offset:5120
  ds_read_b64_tr_b16 v[72:73], v34 offset:2048
  ds_read_b64_tr_b16 v[74:75], v35 offset:2048
  ds_read_b64_tr_b16 v[88:89], v34 offset:6144
  ds_read_b64_tr_b16 v[90:91], v35 offset:6144
  ds_read_b64_tr_b16 v[76:77], v34 offset:3072
  ds_read_b64_tr_b16 v[78:79], v35 offset:3072
  ds_read_b64_tr_b16 v[92:93], v34 offset:7168
  ds_read_b64_tr_b16 v[94:95], v35 offset:7168
  s_waitcnt lgkmcnt(0)
  v_mfma_f32_16x16x32_bf16 v[96:99], v[44:47], v[64:67], 0
  v_mfma_f32_16x16x32_bf16 v[100:103], v[44:47], v[80:83], 0
  v_mfma_f32_16x16x32_bf16 v[96:99], v[44:47], v[68:71], v[96:99]
  v_mfma_f32_16x16x32_bf16 v[100:103], v[44:47], v[84:87], v[100:103]
  v_mfma_f32_16x16x32_bf16 v[96:99], v[44:47], v[72:75], v[96:99]
  v_mfma_f32_16x16x32_bf16 v[100:103], v[44:47], v[88:91], v[100:103]
  s_cmp_ge_u32 s79, 2
  s_cbranch_scc1 L_f_cs3
  v_mfma_f32_16x16x32_bf16 v[96:99], v[44:47], v[76:79], v[96:99]
  v_mfma_f32_16x16x32_bf16 v[100:103], v[44:47], v[92:95], v[100:103]
L_f_cs3:
  s_nop 7
  v_and_b32 v5, 1, v3
  v_cmp_eq_u32 vcc, 0, v5
  s_nop 1
  v_cndmask_b32 v4, v100, v96, vcc
  s_lshl_b32 s68, s79, 2
  s_add_u32 s69, s68, 153088
  v_and_b32 v5, 31, v1
  v_lshlrev_b32 v5, 4, v5
  v_add_u32 v5, s69, v5
  ds_write_b32 v5, v4
  s_waitcnt lgkmcnt(0)
  s_barrier
  v_add_u32 v4, 153088, v48
  ds_read_b128 v[96:99], v4
  ds_read_b128 v[100:103], v4 offset:256
  ds_read_b64_tr_b16 v[104:105], v36
  ds_read_b64_tr_b16 v[106:107], v37
  ds_read_b64_tr_b16 v[108:109], v38
  ds_read_b64_tr_b16 v[110:111], v39
  ds_read_b64_tr_b16 v[112:113], v40
  ds_read_b64_tr_b16 v[114:115], v41
  ds_read_b64_tr_b16 v[116:117], v42
  s_waitcnt lgkmcnt(0)
  v_add_f32 v96, v96, v97
  v_add_f32 v98, v98, v99
  v_add_f32 v96, v96, v98
  v_add_f32 v100, v100, v101
  v_add_f32 v102, v102, v103
  v_add_f32 v100, v100, v102
  v_mov_b32 v148, 0
  s_branch L_f_w
L_f_r:
  buffer_load_dwordx4 v[120:123], v32, s[8:11], 0 offen sc1
  buffer_load_dwordx4 v[124:127], v32, s[8:11], s97 offen sc1
  buffer_load_dwordx4 v[128:131], v32, s[8:11], s98 offen sc1
  buffer_load_dwordx4 v[132:135], v32, s[8:11], s99 offen sc1
L_f_w:
  s_waitcnt vmcnt(0)
  v_max3_u32 v4, v120, v121, v122
  v_max3_u32 v5, v123, v124, v125
  v_max3_u32 v6, v126, v127, v128
  v_max3_u32 v7, v129, v130, v131
  v_max3_u32 v4, v4, v132, v133
  v_max3_u32 v5, v5, v134, v135
  v_max3_u32 v4, v4, v5, v6
  v_max_u32 v4, v4, v7
  v_cmp_eq_u32 vcc, -1, v4
  s_nop 0
  s_and_b64 vcc, exec, vcc
  s_cbranch_vccz L_f_ok
  s_sub_u32 s7, s7, 1
  s_cbranch_scc0 L_f_r
L_f_ok:
  v_mfma_f32_16x16x32_bf16 v[144:147], v[120:123], v[120:123], 0
  v_dot2c_f32_bf16 v148, v120, v44
  v_dot2c_f32_bf16 v148, v121, v44
  v_mfma_f32_16x16x32_bf16 v[136:139], v[120:123], v[64:67], 0
  v_dot2c_f32_bf16 v148, v122, v44
  v_dot2c_f32_bf16 v148, v123, v44
  v_mfma_f32_16x16x32_bf16 v[140:143], v[120:123], v[80:83], 0
  v_mfma_f32_16x16x32_bf16 v[144:147], v[124:127], v[124:127], v[144:147]
  v_dot2c_f32_bf16 v148, v124, v44
  v_dot2c_f32_bf16 v148, v125, v44
  v_mfma_f32_16x16x32_bf16 v[136:139], v[124:127], v[68:71], v[136:139]
  v_dot2c_f32_bf16 v148, v126, v44
  v_dot2c_f32_bf16 v148, v127, v44
  v_mfma_f32_16x16x32_bf16 v[140:143], v[124:127], v[84:87], v[140:143]
  v_mfma_f32_16x16x32_bf16 v[144:147], v[128:131], v[128:131], v[144:147]
  v_dot2c_f32_bf16 v148, v128, v44
  v_dot2c_f32_bf16 v148, v129, v44
  v_mfma_f32_16x16x32_bf16 v[136:139], v[128:131], v[72:75], v[136:139]
  v_dot2c_f32_bf16 v148, v130, v44
  v_dot2c_f32_bf16 v148, v131, v44
  v_mfma_f32_16x16x32_bf16 v[140:143], v[128:131], v[88:91], v[140:143]
  s_cmp_ge_u32 s79, 2
  s_cbranch_scc1 L_f_m3
  v_mfma_f32_16x16x32_bf16 v[144:147], v[132:135], v[132:135], v[144:147]
  v_dot2c_f32_bf16 v148, v132, v44
  v_dot2c_f32_bf16 v148, v133, v44
  v_mfma_f32_16x16x32_bf16 v[136:139], v[132:135], v[76:79], v[136:139]
  v_dot2c_f32_bf16 v148, v134, v44
  v_dot2c_f32_bf16 v148, v135, v44
  v_mfma_f32_16x16x32_bf16 v[140:143], v[132:135], v[92:95], v[140:143]
L_f_m3:
  s_nop 5
  v_add_f32 v144, v144, v145
  v_add_f32 v146, v146, v147
  v_add_f32 v136, v136, v137
  v_add_f32 v138, v138, v139
  v_add_f32 v140, v140, v141
  v_add_f32 v142, v142, v143
  v_add_f32 v144, v144, v146
  v_add_f32 v136, v136, v138
  v_add_f32 v140, v140, v142
  v_permlane16_swap_b32 v144, v148
  s_nop 0
  v_permlane16_swap_b32 v136, v140
  v_add_f32 v144, v144, v148
  v_add_f32 v136, v136, v140
  s_nop 1
  v_permlane32_swap_b32 v136, v144
  v_add_f32 v136, v136, v144
  v_mov_b32 v4, v136
  s_nop 1
  v_add_f32_dpp v4, v4, v4 row_ror:8 row_mask:0xf bank_mask:0xf
  s_nop 1
  v_add_f32_dpp v4, v4, v4 row_ror:4 row_mask:0xf bank_mask:0xf
  s_nop 1
  v_add_f32_dpp v4, v4, v4 row_ror:2 row_mask:0xf bank_mask:0xf
  s_nop 1
  v_add_f32_dpp v4, v4, v4 row_ror:1 row_mask:0xf bank_mask:0xf
  v_cmp_gt_u32 vcc, 2, v3
  s_nop 1
  v_cndmask_b32 v4, v4, v136, vcc
  ds_write_b32 v49, v4
  s_waitcnt lgkmcnt(0)
  s_barrier
  ds_read_b128 v[160:163], v51 offset:512
  ds_read_b128 v[164:167], v51 offset:768
  ds_read_b128 v[152:155], v50
  ds_read_b128 v[156:159], v50 offset:256
  s_waitcnt lgkmcnt(2)
  v_add_f32 v160, v160, v161
  v_add_f32 v162, v162, v163
  v_add_f32 v164, v164, v165
  v_add_f32 v166, v166, v167
  v_add_f32 v160, v160, v162
  v_add_f32 v164, v164, v166
  v_mul_f32 v164, 0x3b124925, v164
  v_mul_f32 v160, 0x3b124925, v160
  v_fma_f32 v160, -v164, v164, v160
  v_max_f32 v160, 0, v160
  v_cvt_pk_bf16_f32 v160, v160, v160
  v_lshlrev_b32 v160, 16, v160
  v_add_f32 v160, 0x3727c5ac, v160
  v_cvt_pk_bf16_f32 v160, v160, v160
  v_lshlrev_b32 v160, 16, v160
  v_sqrt_f32 v160, v160
  s_waitcnt lgkmcnt(0)
  v_add_f32 v152, v152, v153
  v_add_f32 v154, v154, v155
  v_add_f32 v156, v156, v157
  v_add_f32 v158, v158, v159
  v_cvt_pk_bf16_f32 v164, v164, v164
  v_lshlrev_b32 v164, 16, v164
  v_add_f32 v152, v152, v154
  v_add_f32 v156, v156, v158
  v_cvt_pk_bf16_f32 v160, v160, v160
  v_lshlrev_b32 v160, 16, v160
  v_rcp_f32 v160, v160
  v_fma_f32 v152, -v164, v96, v152
  v_fma_f32 v156, -v164, v100, v156
  v_mul_f32 v152, v152, v160
  v_mul_f32 v156, v156, v160
  v_cvt_pk_bf16_f32 v152, v152, v152
  v_lshlrev_b32 v152, 16, v152
  v_cvt_pk_bf16_f32 v156, v156, v156
  v_lshlrev_b32 v156, 16, v156
  v_mul_f32 v4, v152, v152
  v_mov_b32 v5, 0xc0135761
  v_mul_f32 v4, 0xbdd2d3e8, v4
  v_add_f32 v4, v5, v4
  v_mul_f32 v4, v4, v152
  v_exp_f32 v4, v4
  s_nop 0
  v_add_f32 v4, 1.0, v4
  v_rcp_f32 v4, v4
  s_nop 0
  v_mul_f32 v4, v4, v152
  v_cvt_pk_bf16_f32 v4, v4, v4
  v_lshlrev_b32 v4, 16, v4
  v_mul_f32 v4, v4, v156
  s_nop 1
  v_mov_b32_dpp v170, v4 quad_perm:[0,0,0,0] row_mask:0xf bank_mask:0xf
  v_mov_b32_dpp v171, v4 quad_perm:[1,1,1,1] row_mask:0xf bank_mask:0xf
  v_mov_b32_dpp v172, v4 quad_perm:[2,2,2,2] row_mask:0xf bank_mask:0xf
  v_mov_b32_dpp v173, v4 quad_perm:[3,3,3,3] row_mask:0xf bank_mask:0xf
  v_cvt_pk_bf16_f32 v168, v170, v171
  v_cvt_pk_bf16_f32 v169, v172, v173
  s_nop 1
  v_mfma_f32_16x16x16_bf16 v[176:179], v[168:169], v[104:105], 0
  v_mfma_f32_16x16x16_bf16 v[180:183], v[168:169], v[106:107], 0
  v_mfma_f32_16x16x16_bf16 v[184:187], v[168:169], v[108:109], 0
  v_mfma_f32_16x16x16_bf16 v[188:191], v[168:169], v[110:111], 0
  v_mfma_f32_16x16x16_bf16 v[192:195], v[168:169], v[112:113], 0
  v_mfma_f32_16x16x16_bf16 v[196:199], v[168:169], v[114:115], 0
  v_mfma_f32_16x16x16_bf16 v[200:203], v[168:169], v[116:117], 0
  s_nop 2
  v_cndmask_b32 v8, v176, v180, s[80:81]
  v_cndmask_b32 v8, v8, v184, s[82:83]
  v_cndmask_b32 v8, v8, v188, s[84:85]
  v_min_u32 v8, -2, v8
  buffer_store_dword v8, v52, s[8:11], 0 offen sc1
  v_cndmask_b32 v9, v192, v196, s[80:81]
  v_cndmask_b32 v9, v9, v200, s[82:83]
  v_min_u32 v9, -2, v9
  buffer_store_dword v9, v53, s[8:11], 0 offen sc1
  s_endpgm
L_role_o:
  s_cmp_ge_u32 s78, 28
  s_cbranch_scc1 L_end
  s_cmp_lg_u32 s79, 0
  s_cbranch_scc1 L_end
  s_mov_b32 s40, s62
  s_and_b32 s41, s63, 0xffff
  s_mov_b32 s42, 896
  s_mov_b32 s43, 0x20000
  v_mov_b32 v10, 153776
  s_mov_b32 s72, 200000
L_fw22_r:
  ds_read_b32 v16, v10
  s_waitcnt lgkmcnt(0)
  v_readfirstlane_b32 s73, v16
  s_nop 0
  s_cmp_eq_u32 s73, 1
  s_cbranch_scc1 L_fw22_d
  s_sub_u32 s72, s72, 1
  s_cbranch_scc0 L_fw22_r
L_fw22_d:
  v_and_b32 v32, 3, v1
  v_lshrrev_b32 v33, 2, v1
  v_lshlrev_b32 v34, 6, v33
  v_lshl_add_u32 v34, v32, 3, v34
  s_lshr_b32 s68, s78, 1
  s_lshl_b32 s68, s68, 10
  s_and_b32 s69, s78, 1
  s_lshl_b32 s69, s69, 5
  s_add_u32 s68, s68, s69
  s_add_u32 s68, s68, 540672
  v_add_u32 v34, s68, v34
  s_mul_i32 s68, s78, 7168
  s_add_u32 s68, s68, 557056
  v_lshlrev_b32 v35, 4, v1
  v_add_u32 v35, s68, v35
  v_add_u32 v36, 4096, v35
  s_lshl_b32 s68, s78, 5
  v_lshlrev_b32 v4, 3, v1
  v_add_u32 v4, s68, v4
  v_mov_b32 v9, 2147483632
  v_cmp_gt_u32 vcc, 4, v1
  s_nop 1
  v_cndmask_b32 v44, v9, v4, vcc
L_oy_retry:
  buffer_load_dwordx2 v[38:39], v34, s[8:11], 0 offen sc1
  s_waitcnt vmcnt(0)
  v_max3_u32 v4, v38, v39, v39
  v_cmp_eq_u32 vcc, -1, v4
  s_nop 0
  s_and_b64 vcc, exec, vcc
  s_cbranch_vccz L_oy_ok
  s_sub_u32 s7, s7, 1
  s_cbranch_scc0 L_oy_retry
L_oy_ok:
  buffer_load_dwordx4 v[48:51], v35, s[8:11], 0 offen offset:0 sc1
  buffer_load_dwordx4 v[52:55], v35, s[8:11], 0 offen offset:1024 sc1
  buffer_load_dwordx4 v[56:59], v35, s[8:11], 0 offen offset:2048 sc1
  buffer_load_dwordx4 v[60:63], v35, s[8:11], 0 offen offset:3072 sc1
  buffer_load_dwordx4 v[64:67], v36, s[8:11], 0 offen offset:0 sc1
  buffer_load_dwordx4 v[68:71], v36, s[8:11], 0 offen offset:1024 sc1
  buffer_load_dwordx4 v[72:75], v36, s[8:11], 0 offen offset:2048 sc1
  v_lshlrev_b32 v40, 16, v38
  v_and_b32 v41, 0xffff0000, v38
  v_lshlrev_b32 v42, 16, v39
  v_and_b32 v43, 0xffff0000, v39
  v_add_f32_dpp v40, v40, v40 row_ror:4 row_mask:0xf bank_mask:0xf
  v_add_f32_dpp v41, v41, v41 row_ror:4 row_mask:0xf bank_mask:0xf
  v_add_f32_dpp v42, v42, v42 row_ror:4 row_mask:0xf bank_mask:0xf
  v_add_f32_dpp v43, v43, v43 row_ror:4 row_mask:0xf bank_mask:0xf
  v_add_f32_dpp v40, v40, v40 row_ror:8 row_mask:0xf bank_mask:0xf
  v_add_f32_dpp v41, v41, v41 row_ror:8 row_mask:0xf bank_mask:0xf
  v_add_f32_dpp v42, v42, v42 row_ror:8 row_mask:0xf bank_mask:0xf
  v_add_f32_dpp v43, v43, v43 row_ror:8 row_mask:0xf bank_mask:0xf
  v_mov_b32 v8, v40
  v_mov_b32 v9, v41
  v_mov_b32 v10, v42
  v_mov_b32 v11, v43
  v_permlane16_swap_b32 v40, v8
  v_permlane16_swap_b32 v41, v9
  v_permlane16_swap_b32 v42, v10
  v_permlane16_swap_b32 v43, v11
  v_add_f32 v40, v40, v8
  v_add_f32 v41, v41, v9
  v_add_f32 v42, v42, v10
  v_add_f32 v43, v43, v11
  v_mov_b32 v8, v40
  v_mov_b32 v9, v41
  v_mov_b32 v10, v42
  v_mov_b32 v11, v43
  v_permlane32_swap_b32 v40, v8
  v_permlane32_swap_b32 v41, v9
  v_permlane32_swap_b32 v42, v10
  v_permlane32_swap_b32 v43, v11
  v_add_f32 v40, v40, v8
  v_add_f32 v41, v41, v9
  v_add_f32 v42, v42, v10
  v_add_f32 v43, v43, v11
  v_cvt_pk_bf16_f32 v40, v40, v40
  v_lshlrev_b32 v40, 16, v40
  v_cvt_pk_bf16_f32 v41, v41, v41
  v_lshlrev_b32 v41, 16, v41
  v_cvt_pk_bf16_f32 v42, v42, v42
  v_lshlrev_b32 v42, 16, v42
  v_cvt_pk_bf16_f32 v43, v43, v43
  v_lshlrev_b32 v43, 16, v43
  s_branch L_oz_w
L_oz_r:
  buffer_load_dwordx4 v[48:51], v35, s[8:11], 0 offen offset:0 sc1
  buffer_load_dwordx4 v[52:55], v35, s[8:11], 0 offen offset:1024 sc1
  buffer_load_dwordx4 v[56:59], v35, s[8:11], 0 offen offset:2048 sc1
  buffer_load_dwordx4 v[60:63], v35, s[8:11], 0 offen offset:3072 sc1
  buffer_load_dwordx4 v[64:67], v36, s[8:11], 0 offen offset:0 sc1
  buffer_load_dwordx4 v[68:71], v36, s[8:11], 0 offen offset:1024 sc1
  buffer_load_dwordx4 v[72:75], v36, s[8:11], 0 offen offset:2048 sc1
L_oz_w:
  s_waitcnt vmcnt(0)
  v_max3_u32 v4, v48, v49, v50
  v_max3_u32 v5, v51, v52, v53
  v_max3_u32 v6, v54, v55, v56
  v_max3_u32 v7, v57, v58, v59
  v_max3_u32 v4, v4, v60, v61
  v_max3_u32 v5, v5, v62, v63
  v_max3_u32 v6, v6, v64, v65
  v_max3_u32 v7, v7, v66, v67
  v_max3_u32 v4, v4, v68, v69
  v_max3_u32 v5, v5, v70, v71
  v_max3_u32 v6, v6, v72, v73
  v_max3_u32 v7, v7, v74, v75
  v_max3_u32 v4, v4, v5, v6
  v_max_u32 v4, v4, v7
  v_cmp_eq_u32 vcc, -1, v4
  s_nop 0
  s_and_b64 vcc, exec, vcc
  s_cbranch_vccz L_oz_ok
  s_sub_u32 s7, s7, 1
  s_cbranch_scc0 L_oz_r
L_oz_ok:
  v_add_f32 v112, v48, v52
  v_add_f32 v116, v56, v60
  v_add_f32 v120, v64, v68
  v_add_f32 v113, v49, v53
  v_add_f32 v117, v57, v61
  v_add_f32 v121, v65, v69
  v_add_f32 v114, v50, v54
  v_add_f32 v118, v58, v62
  v_add_f32 v122, v66, v70
  v_add_f32 v115, v51, v55
  v_add_f32 v119, v59, v63
  v_add_f32 v123, v67, v71
  v_add_f32 v112, v112, v72
  v_add_f32 v116, v116, v120
  v_add_f32 v113, v113, v73
  v_add_f32 v117, v117, v121
  v_add_f32 v114, v114, v74
  v_add_f32 v118, v118, v122
  v_add_f32 v115, v115, v75
  v_add_f32 v119, v119, v123
  v_add_f32 v112, v112, v116
  v_add_f32 v113, v113, v117
  v_add_f32 v114, v114, v118
  v_add_f32 v115, v115, v119
  v_add_f32_dpp v112, v112, v112 row_ror:4 row_mask:0xf bank_mask:0xf
  v_add_f32_dpp v113, v113, v113 row_ror:4 row_mask:0xf bank_mask:0xf
  v_add_f32_dpp v114, v114, v114 row_ror:4 row_mask:0xf bank_mask:0xf
  v_add_f32_dpp v115, v115, v115 row_ror:4 row_mask:0xf bank_mask:0xf
  v_add_f32_dpp v112, v112, v112 row_ror:8 row_mask:0xf bank_mask:0xf
  v_add_f32_dpp v113, v113, v113 row_ror:8 row_mask:0xf bank_mask:0xf
  v_add_f32_dpp v114, v114, v114 row_ror:8 row_mask:0xf bank_mask:0xf
  v_add_f32_dpp v115, v115, v115 row_ror:8 row_mask:0xf bank_mask:0xf
  v_mov_b32 v8, v112
  v_mov_b32 v9, v113
  v_mov_b32 v10, v114
  v_mov_b32 v11, v115
  v_permlane16_swap_b32 v112, v8
  v_permlane16_swap_b32 v113, v9
  v_permlane16_swap_b32 v114, v10
  v_permlane16_swap_b32 v115, v11
  v_add_f32 v112, v112, v8
  v_add_f32 v113, v113, v9
  v_add_f32 v114, v114, v10
  v_add_f32 v115, v115, v11
  v_mov_b32 v8, v112
  v_mov_b32 v9, v113
  v_mov_b32 v10, v114
  v_mov_b32 v11, v115
  v_permlane32_swap_b32 v112, v8
  v_permlane32_swap_b32 v113, v9
  v_permlane32_swap_b32 v114, v10
  v_permlane32_swap_b32 v115, v11
  v_add_f32 v112, v112, v8
  v_add_f32 v113, v113, v9
  v_add_f32 v114, v114, v10
  v_add_f32 v115, v115, v11
  v_cvt_pk_bf16_f32 v112, v112, v112
  v_lshlrev_b32 v112, 16, v112
  v_cvt_pk_bf16_f32 v113, v113, v113
  v_lshlrev_b32 v113, 16, v113
  v_cvt_pk_bf16_f32 v114, v114, v114
  v_lshlrev_b32 v114, 16, v114
  v_cvt_pk_bf16_f32 v115, v115, v115
  v_lshlrev_b32 v115, 16, v115
  v_add_f32 v112, v112, v40
  v_add_f32 v113, v113, v41
  v_add_f32 v114, v114, v42
  v_add_f32 v115, v115, v43
  v_cvt_pk_bf16_f32 v112, v112, v113
  v_cvt_pk_bf16_f32 v113, v114, v115
  buffer_store_dwordx2 v[112:113], v44, s[40:43], 0 offen sc1
  s_cmp_lg_u32 s78, 0
  s_cbranch_scc1 L_o_noepoch
  v_mov_b32 v6, s6
  v_mov_b32 v7, 2147483632
  v_cmp_eq_u32 vcc, 0, v1
  s_nop 1
  v_cndmask_b32 v7, v7, 0, vcc
  buffer_store_dword v6, v7, s[8:11], 0 offen sc1
L_o_noepoch:
L_end:
  s_endpgm
CODE_END:

.section .rodata,"a"
.p2align 6
.amdhsa_kernel sequential_preLN__sliding_block_cached__glu_gated_geglu__decode_kernel
  .amdhsa_next_free_vgpr 256
  .amdhsa_next_free_sgpr 102
  .amdhsa_accum_offset 256
  .amdhsa_group_segment_fixed_size 0
  .amdhsa_kernarg_size 96
  .amdhsa_user_sgpr_count 2
  .amdhsa_user_sgpr_kernarg_segment_ptr 1
  .amdhsa_system_sgpr_workgroup_id_x 1
  .amdhsa_float_denorm_mode_32 3
.end_amdhsa_kernel
```
